```python
import torch

def _softmax(x, axis=-1):
    return torch.softmax(x, dim=axis)
def _gelu(x):
    return torch.nn.functional.gelu(x, approximate="tanh")
def _silu(x):
    return torch.nn.functional.silu(x)
def _sigmoid(x):
    return torch.sigmoid(x)
def _layernorm(x, axis=-1, eps=1e-5):
    m = x.mean(dim=axis, keepdim=True)
    v = x.var(dim=axis, keepdim=True, unbiased=False)
    return (x - m) / torch.sqrt(v + eps)
def _scatter_add(tgt, idx, src, axis=0):
    return tgt.clone().index_add_(axis, idx, src)
def _segment_sum(src, seg, n):
    out = torch.zeros((n,) + src.shape[1:], dtype=src.dtype)
    return out.index_add_(0, seg, src)
def _pad(x, pw):
    flat = tuple(v for pair in reversed(pw) for v in pair)
    return torch.nn.functional.pad(x, flat)

kernel_name = 'standalone__paged_block_table_kv_pagedattention__sampling'

def setup_inputs():

    _w = (lambda a: (lambda t: t.to(torch.bfloat16) if t.is_floating_point() else t)(torch.as_tensor(a)))
    B, Hq, Hkv, Sq, Skv, D = 8, 32, 4, 32, 8192, 128
    bs = 16
    nbps = max(1, Skv // bs)
    num_phys = B * nbps + 4
    bt = torch.randperm(num_phys)[: B * nbps].reshape(B, nbps).to(torch.int64)
    cl = (nbps * bs - (torch.arange(1, B + 1, dtype=torch.int64) * 2654435761) % max(1, nbps * bs // 2)).to(torch.int64)
    return {
        "q": _w((lambda *s: torch.randn(*s, dtype=torch.bfloat16) * 0.8)(B, Hq, Sq, D)),
        "k_cache": _w((lambda *s: torch.randn(*s, dtype=torch.bfloat16) * 0.8)(num_phys, bs, Hkv, D)),
        "v_cache": _w((lambda *s: torch.randn(*s, dtype=torch.bfloat16) * 0.05)(num_phys, bs, Hkv, D)),
        "block_table": _w(bt),
        "context_lens": _w(cl),
    }

def reference(q, k_cache, v_cache, block_table, context_lens):
    B, Hq, Sq, D = q.shape
    bs = k_cache.shape[1]
    Hkv = k_cache.shape[2]
    nbps = block_table.shape[1]
    Skv = nbps * bs
    bt = block_table.reshape(-1)
    k = (lambda x, *d: x.permute(*d))(k_cache[bt].reshape(B, Skv, Hkv, D), 0, 2, 1, 3)
    v = (lambda x, *d: x.permute(*d))(v_cache[bt].reshape(B, Skv, Hkv, D), 0, 2, 1, 3)
    g = Hq // Hkv
    qg = q.reshape(B, Hkv, g, Sq, D)
    scores = torch.einsum("bhgqd,bhkd->bhgqk", qg, k) * (D ** -0.5)
    pos = torch.arange(Skv)
    msk = pos[None, :] < context_lens[:, None]
    scores = torch.where(msk[:, None, None, None, :], scores, -1e9)
    p = _softmax(scores, axis=-1)
    out = torch.einsum("bhgqk,bhkd->bhgqd", p, v)
    return out.reshape(B, Hq, Sq, D)
```

```asm
; @launch grid=(256,1,1) block=(256,1,1) lds=163840
.amdgcn_target "amdgcn-amd-amdhsa--gfx950"
.text
.globl standalone__paged_block_table_kv_pagedattention__sampling_kernel
.p2align 8
.type standalone__paged_block_table_kv_pagedattention__sampling_kernel,@function
standalone__paged_block_table_kv_pagedattention__sampling_kernel:
    s_cmp_ge_u32 s2, 256
    s_cbranch_scc1 L_end
    s_load_dwordx16 s[4:19], s[0:1], 0
    v_lshrrev_b32 v240, 6, v0
    v_and_b32 v239, 63, v0
    v_readfirstlane_b32 s40, v240
    s_lshr_b32 s41, s2, 1
    s_and_b32 s41, s41, 3
    s_and_b32 s60, s2, 1
    s_lshl_b32 s60, s60, 5
    s_lshr_b32 s42, s2, 3
    s_or_b32 s42, s42, s60
    v_and_b32 v241, 7, v239
    v_lshlrev_b32 v241, 2, v241
    v_lshlrev_b32 v242, 7, v239

    s_memrealtime s[74:75]
    s_and_b32 s60, s40, 1
    s_lshl_b32 s60, s60, 3
    s_lshl_b32 s61, s41, 8
    v_lshrrev_b32 v251, 4, v239
    v_and_b32 v252, 15, v239
    v_add_u32 v253, s60, v251
    v_xor_b32 v254, v252, v253
    v_lshlrev_b32 v254, 4, v254
    v_lshl_add_u32 v254, v253, 10, v254
    v_add_u32 v220, s61, v254
    v_add_u32 v253, 4, v253
    v_xor_b32 v254, v252, v253
    v_lshlrev_b32 v254, 4, v254
    v_lshl_add_u32 v254, v253, 10, v254
    v_add_u32 v254, s61, v254
    v_add_u32 v221, 0xfffffc00, v254
    v_lshlrev_b32 v254, 2, v251
    v_xor_b32 v254, v252, v254
    v_lshlrev_b32 v254, 4, v254
    v_add_u32 v253, s60, v251
    v_lshl_add_u32 v254, v253, 10, v254
    v_add_u32 v222, s61, v254
    v_add_u32 v223, 0xc00, v222
    s_lshl_b32 s50, s40, 11
    s_add_u32 s51, s50, 0x10000
    s_mov_b32 s52, 0x45800000
    s_mov_b32 s52, 0x45800000
    s_mov_b32 s44, 0
    s_mov_b32 s47, 9
    v_lshrrev_b32 v251, 5, v239
    v_lshlrev_b32 v255, 2, v251
    v_lshrrev_b32 v253, 4, v239
    v_xor_b32 v254, v252, v253
    v_lshlrev_b32 v254, 4, v254
    v_lshl_add_u32 v233, v253, 8, v254
    v_xor_b32 v234, 64, v233
    v_xor_b32 v235, 0x80, v233
    v_xor_b32 v236, 0xc0, v233
    v_lshlrev_b32 v237, 3, v239
    s_lshl_b32 s54, s40, 13
    s_add_u32 s54, s54, 0x20000
    s_and_b32 s60, s40, 1
    s_lshl_b32 s60, s60, 13
    s_lshr_b32 s61, s40, 1
    s_lshl_b32 s61, s61, 16
    s_add_u32 s60, s60, s61
    s_add_u32 s55, s60, 0xc000
    s_waitcnt lgkmcnt(0)

    s_mov_b32 s32, s12
    s_and_b32 s33, s13, 0xffff
    s_mov_b32 s34, 0x20
    s_mov_b32 s35, 0x20000

    buffer_load_dword v250, v241, s[32:35], 0 offen
    s_mov_b32 s76, s10
    s_and_b32 s77, s11, 0xffff
    s_mov_b32 s78, 0x4000
    s_mov_b32 s79, 0x20000

    s_mov_b32 s28, s4
    s_and_b32 s29, s5, 0xffff
    s_mov_b32 s30, 0x200000
    s_mov_b32 s31, 0x20000

    s_lshr_b32 s60, s2, 3
    s_lshr_b32 s61, s60, 2
    s_lshl_b32 s61, s61, 18
    s_and_b32 s62, s60, 3
    s_lshl_b32 s62, s62, 14
    s_add_u32 s61, s61, s62
    s_lshl_b32 s62, s41, 16
    s_add_u32 s61, s61, s62
    s_lshl_b32 s62, s40, 13
    s_add_u32 s61, s61, s62
    s_lshl_b32 s60, s60, 9
    s_cmp_lt_u32 s40, 2
    s_cselect_b32 s61, s61, 0x80000000
    s_cmp_eq_u32 s40, 2
    s_cselect_b32 s60, s60, 0x80000000
    v_min_u32 v243, 0x180, v242
    buffer_load_dword v192, v242, s[28:31], s61 offen
    buffer_load_dword v193, v243, s[76:79], s60 offen

    s_mov_b32 s20, s6
    s_and_b32 s21, s7, 0xffff
    s_mov_b32 s22, 0x4010000
    s_mov_b32 s23, 0x20000

    s_mov_b32 s24, s8
    s_and_b32 s25, s9, 0xffff
    s_mov_b32 s26, 0x4010000
    s_mov_b32 s27, 0x20000

    s_mov_b32 s36, s18
    s_and_b32 s37, s19, 0xffff
    s_mov_b32 s38, 0x1190000
    s_mov_b32 s39, 0x20000

    v_and_b32 v252, 31, v239
    v_and_b32 v253, 15, v239
    v_xor_b32 v253, v253, v251
    v_lshlrev_b32 v253, 4, v253
    v_lshl_add_u32 v208, v252, 8, v253

    v_xor_b32 v209, 32, v208
    v_xor_b32 v210, 64, v208
    v_xor_b32 v211, 96, v208
    v_xor_b32 v212, 128, v208
    v_xor_b32 v213, 160, v208
    v_xor_b32 v214, 192, v208
    v_xor_b32 v215, 224, v208
    v_bfe_u32 v252, v239, 2, 2
    v_add_u32 v253, v255, v252
    v_lshlrev_b32 v253, 8, v253
    v_bfe_u32 v254, v239, 4, 1
    v_lshl_add_u32 v253, v254, 5, v253
    v_and_b32 v254, 3, v239
    v_lshl_add_u32 v253, v254, 3, v253
    v_add_u32 v253, 0x10000, v253
    v_lshl_add_u32 v216, v252, 6, v253

    v_xor_b32 v217, 64, v216
    v_xor_b32 v218, 128, v216
    v_xor_b32 v219, 192, v216
    s_waitcnt vmcnt(2)
    v_add_u32 v240, -1, v250
    v_min_u32 v240, 0x1fff, v240
    v_lshrrev_b32 v241, 5, v240
    v_add_u32 v241, 1, v241

    s_nop 1
    v_add_u32_dpp v248, v241, v241 quad_perm:[1,0,3,2] row_mask:0xf bank_mask:0xf
    s_nop 1
    v_add_u32_dpp v242, v248, v248 quad_perm:[2,3,0,1] row_mask:0xf bank_mask:0xf
    s_nop 1
    v_add_u32_dpp v242, v242, v242 row_half_mirror row_mask:0xf bank_mask:0xf

    v_add_u32 v242, 63, v242
    v_lshrrev_b32 v242, 6, v242
    v_lshrrev_b32 v248, 3, v239
    v_add_u32 v242, v242, v248
    v_cvt_f32_u32 v248, v242
    v_rcp_f32 v248, v248
    v_add3_u32 v249, v241, v242, -1
    v_cvt_f32_u32 v249, v249
    v_add_f32 v249, 0.5, v249
    v_mul_f32 v249, v249, v248
    v_cvt_u32_f32 v243, v249

    s_nop 1
    v_add_u32_dpp v248, v243, v243 quad_perm:[1,0,3,2] row_mask:0xf bank_mask:0xf
    s_nop 1
    v_add_u32_dpp v244, v248, v248 quad_perm:[2,3,0,1] row_mask:0xf bank_mask:0xf
    s_nop 1
    v_add_u32_dpp v244, v244, v244 row_half_mirror row_mask:0xf bank_mask:0xf

    s_nop 1
    v_add_u32_dpp v245, v243, v243 row_shr:1 row_mask:0xf bank_mask:0xf bound_ctrl:0
    v_cvt_f32_u32 v248, v243
    v_rcp_f32 v248, v248
    v_add_u32_dpp v245, v245, v245 row_shr:2 row_mask:0xf bank_mask:0xf bound_ctrl:0
    v_cvt_f32_u32 v249, v241
    v_add_f32 v249, 0.5, v249
    v_add_u32_dpp v245, v245, v245 row_shr:4 row_mask:0xf bank_mask:0xf bound_ctrl:0
    v_mul_f32 v249, v249, v248
    v_cvt_u32_f32 v246, v249
    v_add_u32_dpp v245, v245, v245 row_shr:8 row_mask:0xf bank_mask:0xf bound_ctrl:0
    v_mul_u32_u24 v248, v246, v243
    v_sub_u32 v247, v241, v248
    v_mov_b32_dpp v249, v244 row_shr:8 row_mask:0xf bank_mask:0xf bound_ctrl:0
    v_sub_u32 v245, v245, v249
    v_cmp_ge_u32 vcc, 64, v244
    s_ff1_i32_b64 s60, vcc
    s_mov_b64 s[62:63], 0xff
    s_lshl_b64 s[62:63], s[62:63], s60

    v_cmp_lt_u32 vcc, s42, v245
    s_and_b64 vcc, vcc, s[62:63]
    s_cbranch_scc0 L_end
    s_ff1_i32_b64 s60, vcc
    s_and_b32 s80, s60, 7
    v_readlane_b32 s64, v243, s60
    v_readlane_b32 s65, v245, s60
    v_readlane_b32 s68, v246, s60
    v_readlane_b32 s69, v247, s60
    v_readlane_b32 s66, v240, s60
    v_readlane_b32 s67, v250, s60
    s_lshl_b32 s62, s80, 5
    s_lshl_b32 s61, s41, 3
    s_add_u32 s62, s62, s61
    s_lshl_b32 s61, s40, 1
    s_add_u32 s62, s62, s61
    s_lshl_b32 s62, s62, 13
    s_add_u32 s63, s62, 0x2000
    s_sub_u32 s70, s65, s64
    s_sub_u32 s70, s42, s70
    s_mul_i32 s81, s70, s68
    s_min_u32 s60, s70, s69
    s_add_u32 s81, s81, s60

    s_lshl_b32 s60, s80, 9
    s_lshl_b32 s61, s81, 1
    s_add_u32 s60, s60, s61
    s_lshr_b32 s61, s40, 1
    s_add_u32 s60, s60, s61
    s_lshl_b32 s60, s60, 2
    buffer_load_dword v224, v237, s[76:79], s60 offen

    s_mov_b32 s84, s62
    s_mov_b32 s85, s63

    s_add_u32 m0, s54, 0
    s_add_u32 s86, s84, 0
    buffer_load_dwordx4 v233, s[28:31], s86 offen offset:0 lds
    buffer_load_dwordx4 v234, s[28:31], s86 offen offset:1024 lds
    buffer_load_dwordx4 v235, s[28:31], s86 offen offset:2048 lds
    buffer_load_dwordx4 v236, s[28:31], s86 offen offset:3072 lds
    s_add_u32 m0, s54, 4096
    s_add_u32 s86, s84, 4096
    buffer_load_dwordx4 v233, s[28:31], s86 offen offset:0 lds
    buffer_load_dwordx4 v234, s[28:31], s86 offen offset:1024 lds
    buffer_load_dwordx4 v235, s[28:31], s86 offen offset:2048 lds
    buffer_load_dwordx4 v236, s[28:31], s86 offen offset:3072 lds
    s_mov_b32 s32, s16
    s_and_b32 s33, s17, 0xffff
    s_mov_b32 s34, 0x100
    s_mov_b32 s35, 0x20000

    s_or_b32 s74, s74, 1
    v_mov_b32 v248, s74
    v_mov_b32 v249, s75
    v_mov_b32 v247, 0
    s_or_b32 s60, s2, s40
    s_cmp_eq_u32 s60, 0
    s_cselect_b32 s60, 0, 0x80000000
    s_mov_b64 exec, 1
    buffer_store_dwordx2 v[248:249], v247, s[32:35], s60 offen sc1
    s_mov_b64 exec, -1

    s_cmp_lt_u32 s70, s69
    s_addc_u32 s43, s68, 0

    s_min_u32 s43, s43, 54
    s_and_b32 s46, s66, 31
    s_add_u32 s46, s46, 1
    s_add_u32 s60, s70, 1
    s_cmp_eq_u32 s60, s64
    s_cselect_b32 s46, s46, 32
    s_sub_u32 s45, s43, 2
    s_cmp_lt_u32 s46, 32
    s_cselect_b32 s45, s45, 0x7fffffff
    s_mov_b32 s56, 0x3e0293ee
    s_cmp_lt_i32 s67, 1
    s_cselect_b32 s56, 0, s56
    s_mov_b32 s57, s56
    s_lshl_b32 s83, s41, 6
    s_add_u32 s83, s83, s42
    s_min_u32 s82, s64, 64
    s_mov_b32 s3, s70
    s_sub_u32 s53, s83, s70

    v_mov_b32 v64, 0
    v_mov_b32 v65, 0
    v_mov_b32 v66, 0
    v_mov_b32 v67, 0
    v_mov_b32 v68, 0
    v_mov_b32 v69, 0
    v_mov_b32 v70, 0
    v_mov_b32 v71, 0
    v_mov_b32 v72, 0
    v_mov_b32 v73, 0
    v_mov_b32 v74, 0
    v_mov_b32 v75, 0
    v_mov_b32 v76, 0
    v_mov_b32 v77, 0
    v_mov_b32 v78, 0
    v_mov_b32 v79, 0
    v_mov_b32 v80, 0
    v_mov_b32 v81, 0
    v_mov_b32 v82, 0
    v_mov_b32 v83, 0
    v_mov_b32 v84, 0
    v_mov_b32 v85, 0
    v_mov_b32 v86, 0
    v_mov_b32 v87, 0
    v_mov_b32 v88, 0
    v_mov_b32 v89, 0
    v_mov_b32 v90, 0
    v_mov_b32 v91, 0
    v_mov_b32 v92, 0
    v_mov_b32 v93, 0
    v_mov_b32 v94, 0
    v_mov_b32 v95, 0
    v_mov_b32 v96, 0
    v_mov_b32 v97, 0
    v_mov_b32 v98, 0
    v_mov_b32 v99, 0
    v_mov_b32 v100, 0
    v_mov_b32 v101, 0
    v_mov_b32 v102, 0
    v_mov_b32 v103, 0
    v_mov_b32 v104, 0
    v_mov_b32 v105, 0
    v_mov_b32 v106, 0
    v_mov_b32 v107, 0
    v_mov_b32 v108, 0
    v_mov_b32 v109, 0
    v_mov_b32 v110, 0
    v_mov_b32 v111, 0
    v_mov_b32 v112, 0
    v_mov_b32 v113, 0
    v_mov_b32 v114, 0
    v_mov_b32 v115, 0
    v_mov_b32 v116, 0
    v_mov_b32 v117, 0
    v_mov_b32 v118, 0
    v_mov_b32 v119, 0
    v_mov_b32 v120, 0
    v_mov_b32 v121, 0
    v_mov_b32 v122, 0
    v_mov_b32 v123, 0
    v_mov_b32 v124, 0
    v_mov_b32 v125, 0
    v_mov_b32 v126, 0
    v_mov_b32 v127, 0
    v_mov_b32 v253, 0x80000000
    v_cmp_gt_u32 vcc, s43, v239
    s_waitcnt vmcnt(9)
    v_lshlrev_b32 v224, 14, v224
    v_cndmask_b32 v224, v253, v224, vcc
    s_nop 0

    v_readlane_b32 s60, v224, 0
    v_readlane_b32 s61, v224, 1
    v_readlane_b32 s62, v224, 2
    v_readlane_b32 s63, v224, 3
    v_readlane_b32 s64, v224, 4
    v_readlane_b32 s65, v224, 5
    v_readlane_b32 s66, v224, 6
    v_readlane_b32 s67, v224, 7
    v_readlane_b32 s68, v224, 8
    s_nop 3
    s_add_u32 m0, s50, 0
    s_nop 0
    buffer_load_dwordx4 v220, s[20:23], s60 offen nt lds
    buffer_load_dwordx4 v221, s[20:23], s60 offen offset:1024 nt lds
    s_add_u32 m0, s55, 0
    s_add_u32 s86, s85, 0
    buffer_load_dwordx4 v233, s[28:31], s86 offen offset:0 lds
    buffer_load_dwordx4 v234, s[28:31], s86 offen offset:1024 lds
    buffer_load_dwordx4 v235, s[28:31], s86 offen offset:2048 lds
    buffer_load_dwordx4 v236, s[28:31], s86 offen offset:3072 lds
    s_add_u32 m0, s55, 4096
    s_add_u32 s86, s85, 4096
    buffer_load_dwordx4 v233, s[28:31], s86 offen offset:0 lds
    buffer_load_dwordx4 v234, s[28:31], s86 offen offset:1024 lds
    buffer_load_dwordx4 v235, s[28:31], s86 offen offset:2048 lds
    buffer_load_dwordx4 v236, s[28:31], s86 offen offset:3072 lds
    s_lshl_b32 s86, s3, 2
    v_add_u32 v246, s86, v239
    v_lshlrev_b32 v246, 4, v246
    v_cvt_f32_u32 v246, v246
    v_cvt_f32_u32 v247, s82
    v_rcp_f32 v247, v247
    v_add_f32 v246, 0.5, v246
    s_add_u32 s87, s40, 1
    v_mul_f32 v246, v246, v247
    v_cvt_u32_f32 v246, v246
    s_lshl_b32 s71, s40, 4
    v_readlane_b32 s85, v246, 0
    v_readlane_b32 s84, v246, 4
    v_readlane_b32 s87, v246, s87
    v_readlane_b32 s86, v246, s40
    s_sub_u32 s84, s84, s85
    s_bfm_b64 s[72:73], s84, s85
    s_lshr_b64 s[72:73], s[72:73], s71
    s_cmp_ge_u32 s82, 3
    s_cselect_b32 s84, s72, 0

    v_mov_b32 v160, 0
    v_mov_b32 v161, 0
    v_mov_b32 v162, 0
    v_mov_b32 v163, 0
    v_mov_b32 v164, 0
    v_mov_b32 v165, 0
    v_mov_b32 v166, 0
    v_mov_b32 v167, 0
    v_mov_b32 v168, 0
    v_mov_b32 v169, 0
    v_mov_b32 v170, 0
    v_mov_b32 v171, 0
    v_mov_b32 v172, 0
    v_mov_b32 v173, 0
    v_mov_b32 v174, 0
    v_mov_b32 v175, 0
    v_mov_b32 v176, 0
    v_mov_b32 v177, 0
    v_mov_b32 v178, 0
    v_mov_b32 v179, 0
    v_mov_b32 v180, 0
    v_mov_b32 v181, 0
    v_mov_b32 v182, 0
    v_mov_b32 v183, 0
    v_mov_b32 v184, 0
    v_mov_b32 v185, 0
    v_mov_b32 v186, 0
    v_mov_b32 v187, 0
    v_mov_b32 v188, 0
    v_mov_b32 v189, 0
    v_mov_b32 v190, 0
    v_mov_b32 v191, 0
    v_mov_b32 v192, 0
    v_mov_b32 v193, 0
    v_mov_b32 v194, 0
    v_mov_b32 v195, 0
    v_mov_b32 v196, 0
    v_mov_b32 v197, 0
    v_mov_b32 v198, 0
    v_mov_b32 v199, 0
    v_mov_b32 v200, 0
    v_mov_b32 v201, 0
    v_mov_b32 v202, 0
    v_mov_b32 v203, 0
    v_mov_b32 v204, 0
    v_mov_b32 v205, 0
    v_mov_b32 v206, 0
    v_mov_b32 v207, 0
    v_mov_b32 v32, 0
    v_mov_b32 v33, 0
    v_mov_b32 v34, 0
    v_mov_b32 v35, 0
    v_mov_b32 v36, 0
    v_mov_b32 v37, 0
    v_mov_b32 v38, 0
    v_mov_b32 v39, 0
    v_mov_b32 v40, 0
    v_mov_b32 v41, 0
    v_mov_b32 v42, 0
    v_mov_b32 v43, 0
    v_mov_b32 v44, 0
    v_mov_b32 v45, 0
    v_mov_b32 v46, 0
    v_mov_b32 v47, 0
    v_mov_b32 v48, 0
    v_mov_b32 v49, 0
    v_mov_b32 v50, 0
    v_mov_b32 v51, 0
    v_mov_b32 v52, 0
    v_mov_b32 v53, 0
    v_mov_b32 v54, 0
    v_mov_b32 v55, 0
    v_mov_b32 v56, 0
    v_mov_b32 v57, 0
    v_mov_b32 v58, 0
    v_mov_b32 v59, 0
    v_mov_b32 v60, 0
    v_mov_b32 v61, 0
    v_mov_b32 v62, 0
    v_mov_b32 v63, 0
    v_accvgpr_write_b32 a96, 0
    v_accvgpr_write_b32 a97, 0
    v_accvgpr_write_b32 a98, 0
    v_accvgpr_write_b32 a99, 0
    v_accvgpr_write_b32 a100, 0
    v_accvgpr_write_b32 a101, 0
    v_accvgpr_write_b32 a102, 0
    v_accvgpr_write_b32 a103, 0
    v_accvgpr_write_b32 a104, 0
    v_accvgpr_write_b32 a105, 0
    v_accvgpr_write_b32 a106, 0
    v_accvgpr_write_b32 a107, 0
    v_accvgpr_write_b32 a108, 0
    v_accvgpr_write_b32 a109, 0
    v_accvgpr_write_b32 a110, 0
    v_accvgpr_write_b32 a111, 0
    v_accvgpr_write_b32 a112, 0
    v_accvgpr_write_b32 a113, 0
    v_accvgpr_write_b32 a114, 0
    v_accvgpr_write_b32 a115, 0
    v_accvgpr_write_b32 a116, 0
    v_accvgpr_write_b32 a117, 0
    v_accvgpr_write_b32 a118, 0
    v_accvgpr_write_b32 a119, 0
    v_accvgpr_write_b32 a120, 0
    v_accvgpr_write_b32 a121, 0
    v_accvgpr_write_b32 a122, 0
    v_accvgpr_write_b32 a123, 0
    v_accvgpr_write_b32 a124, 0
    v_accvgpr_write_b32 a125, 0
    v_accvgpr_write_b32 a126, 0
    v_accvgpr_write_b32 a127, 0
    v_mov_b32 v225, 0
    v_mov_b32 v226, 0
    s_cmp_eq_u32 s45, -1
    s_cbranch_scc0 L_nopatch0
    s_call_b64 s[58:59], L_sub_patch

L_nopatch0:
    s_waitcnt vmcnt(11)
    v_add_u32 v244, s54, v208
    v_add_u32 v245, s54, v209
    v_add_u32 v246, s54, v210
    v_add_u32 v247, s54, v211
    v_add_u32 v248, s54, v212
    v_add_u32 v249, s54, v213
    v_add_u32 v250, s54, v214
    v_add_u32 v251, s54, v215
    ds_read_b128 v[0:3], v244
    ds_read_b128 v[4:7], v245
    ds_read_b128 v[8:11], v246
    ds_read_b128 v[12:15], v247
    ds_read_b128 v[16:19], v248
    ds_read_b128 v[20:23], v249
    ds_read_b128 v[24:27], v250
    ds_read_b128 v[28:31], v251
    s_waitcnt lgkmcnt(7)
    v_lshlrev_b32 v240, 16, v0
    v_and_b32 v241, 0xffff0000, v0
    v_pk_mul_f32 v[240:241], v[240:241], s[56:57]
    v_cvt_pk_bf16_f32 v240, v240, v241
    v_accvgpr_write_b32 a0, v240
    v_lshlrev_b32 v242, 16, v1
    v_and_b32 v243, 0xffff0000, v1
    v_pk_mul_f32 v[242:243], v[242:243], s[56:57]
    v_cvt_pk_bf16_f32 v242, v242, v243
    v_accvgpr_write_b32 a1, v242
    v_lshlrev_b32 v240, 16, v2
    v_and_b32 v241, 0xffff0000, v2
    v_pk_mul_f32 v[240:241], v[240:241], s[56:57]
    v_cvt_pk_bf16_f32 v240, v240, v241
    v_accvgpr_write_b32 a2, v240
    v_lshlrev_b32 v242, 16, v3
    v_and_b32 v243, 0xffff0000, v3
    v_pk_mul_f32 v[242:243], v[242:243], s[56:57]
    v_cvt_pk_bf16_f32 v242, v242, v243
    v_accvgpr_write_b32 a3, v242
    s_waitcnt lgkmcnt(6)
    v_lshlrev_b32 v240, 16, v4
    v_and_b32 v241, 0xffff0000, v4
    v_pk_mul_f32 v[240:241], v[240:241], s[56:57]
    v_cvt_pk_bf16_f32 v240, v240, v241
    v_accvgpr_write_b32 a4, v240
    v_lshlrev_b32 v242, 16, v5
    v_and_b32 v243, 0xffff0000, v5
    v_pk_mul_f32 v[242:243], v[242:243], s[56:57]
    v_cvt_pk_bf16_f32 v242, v242, v243
    v_accvgpr_write_b32 a5, v242
    v_lshlrev_b32 v240, 16, v6
    v_and_b32 v241, 0xffff0000, v6
    v_pk_mul_f32 v[240:241], v[240:241], s[56:57]
    v_cvt_pk_bf16_f32 v240, v240, v241
    v_accvgpr_write_b32 a6, v240
    v_lshlrev_b32 v242, 16, v7
    v_and_b32 v243, 0xffff0000, v7
    v_pk_mul_f32 v[242:243], v[242:243], s[56:57]
    v_cvt_pk_bf16_f32 v242, v242, v243
    v_accvgpr_write_b32 a7, v242
    s_add_u32 m0, s50, 8192
    s_nop 0
    buffer_load_dwordx4 v220, s[20:23], s61 offen nt lds
    buffer_load_dwordx4 v221, s[20:23], s61 offen offset:1024 nt lds
    s_waitcnt lgkmcnt(5)
    v_lshlrev_b32 v240, 16, v8
    v_and_b32 v241, 0xffff0000, v8
    v_pk_mul_f32 v[240:241], v[240:241], s[56:57]
    v_cvt_pk_bf16_f32 v240, v240, v241
    v_accvgpr_write_b32 a8, v240
    v_lshlrev_b32 v242, 16, v9
    v_and_b32 v243, 0xffff0000, v9
    v_pk_mul_f32 v[242:243], v[242:243], s[56:57]
    v_cvt_pk_bf16_f32 v242, v242, v243
    v_accvgpr_write_b32 a9, v242
    v_lshlrev_b32 v240, 16, v10
    v_and_b32 v241, 0xffff0000, v10
    v_pk_mul_f32 v[240:241], v[240:241], s[56:57]
    v_cvt_pk_bf16_f32 v240, v240, v241
    v_accvgpr_write_b32 a10, v240
    v_lshlrev_b32 v242, 16, v11
    v_and_b32 v243, 0xffff0000, v11
    v_pk_mul_f32 v[242:243], v[242:243], s[56:57]
    v_cvt_pk_bf16_f32 v242, v242, v243
    v_accvgpr_write_b32 a11, v242
    s_waitcnt lgkmcnt(4)
    v_lshlrev_b32 v240, 16, v12
    v_and_b32 v241, 0xffff0000, v12
    v_pk_mul_f32 v[240:241], v[240:241], s[56:57]
    v_cvt_pk_bf16_f32 v240, v240, v241
    v_accvgpr_write_b32 a12, v240
    v_lshlrev_b32 v242, 16, v13
    v_and_b32 v243, 0xffff0000, v13
    v_pk_mul_f32 v[242:243], v[242:243], s[56:57]
    v_cvt_pk_bf16_f32 v242, v242, v243
    v_accvgpr_write_b32 a13, v242
    v_lshlrev_b32 v240, 16, v14
    v_and_b32 v241, 0xffff0000, v14
    v_pk_mul_f32 v[240:241], v[240:241], s[56:57]
    v_cvt_pk_bf16_f32 v240, v240, v241
    v_accvgpr_write_b32 a14, v240
    v_lshlrev_b32 v242, 16, v15
    v_and_b32 v243, 0xffff0000, v15
    v_pk_mul_f32 v[242:243], v[242:243], s[56:57]
    v_cvt_pk_bf16_f32 v242, v242, v243
    v_accvgpr_write_b32 a15, v242
    s_add_u32 m0, s51, 0
    s_nop 0
    buffer_load_dwordx4 v222, s[24:27], s60 offen nt lds
    buffer_load_dwordx4 v223, s[24:27], s60 offen offset:1024 nt lds
    s_waitcnt lgkmcnt(3)
    v_lshlrev_b32 v240, 16, v16
    v_and_b32 v241, 0xffff0000, v16
    v_pk_mul_f32 v[240:241], v[240:241], s[56:57]
    v_cvt_pk_bf16_f32 v240, v240, v241
    v_accvgpr_write_b32 a16, v240
    v_lshlrev_b32 v242, 16, v17
    v_and_b32 v243, 0xffff0000, v17
    v_pk_mul_f32 v[242:243], v[242:243], s[56:57]
    v_cvt_pk_bf16_f32 v242, v242, v243
    v_accvgpr_write_b32 a17, v242
    v_lshlrev_b32 v240, 16, v18
    v_and_b32 v241, 0xffff0000, v18
    v_pk_mul_f32 v[240:241], v[240:241], s[56:57]
    v_cvt_pk_bf16_f32 v240, v240, v241
    v_accvgpr_write_b32 a18, v240
    v_lshlrev_b32 v242, 16, v19
    v_and_b32 v243, 0xffff0000, v19
    v_pk_mul_f32 v[242:243], v[242:243], s[56:57]
    v_cvt_pk_bf16_f32 v242, v242, v243
    v_accvgpr_write_b32 a19, v242
    s_waitcnt lgkmcnt(2)
    v_lshlrev_b32 v240, 16, v20
    v_and_b32 v241, 0xffff0000, v20
    v_pk_mul_f32 v[240:241], v[240:241], s[56:57]
    v_cvt_pk_bf16_f32 v240, v240, v241
    v_accvgpr_write_b32 a20, v240
    v_lshlrev_b32 v242, 16, v21
    v_and_b32 v243, 0xffff0000, v21
    v_pk_mul_f32 v[242:243], v[242:243], s[56:57]
    v_cvt_pk_bf16_f32 v242, v242, v243
    v_accvgpr_write_b32 a21, v242
    v_lshlrev_b32 v240, 16, v22
    v_and_b32 v241, 0xffff0000, v22
    v_pk_mul_f32 v[240:241], v[240:241], s[56:57]
    v_cvt_pk_bf16_f32 v240, v240, v241
    v_accvgpr_write_b32 a22, v240
    v_lshlrev_b32 v242, 16, v23
    v_and_b32 v243, 0xffff0000, v23
    v_pk_mul_f32 v[242:243], v[242:243], s[56:57]
    v_cvt_pk_bf16_f32 v242, v242, v243
    v_accvgpr_write_b32 a23, v242
    s_waitcnt lgkmcnt(1)
    v_lshlrev_b32 v240, 16, v24
    v_and_b32 v241, 0xffff0000, v24
    v_pk_mul_f32 v[240:241], v[240:241], s[56:57]
    v_cvt_pk_bf16_f32 v240, v240, v241
    v_accvgpr_write_b32 a24, v240
    v_lshlrev_b32 v242, 16, v25
    v_and_b32 v243, 0xffff0000, v25
    v_pk_mul_f32 v[242:243], v[242:243], s[56:57]
    v_cvt_pk_bf16_f32 v242, v242, v243
    v_accvgpr_write_b32 a25, v242
    v_lshlrev_b32 v240, 16, v26
    v_and_b32 v241, 0xffff0000, v26
    v_pk_mul_f32 v[240:241], v[240:241], s[56:57]
    v_cvt_pk_bf16_f32 v240, v240, v241
    v_accvgpr_write_b32 a26, v240
    v_lshlrev_b32 v242, 16, v27
    v_and_b32 v243, 0xffff0000, v27
    v_pk_mul_f32 v[242:243], v[242:243], s[56:57]
    v_cvt_pk_bf16_f32 v242, v242, v243
    v_accvgpr_write_b32 a27, v242
    s_waitcnt lgkmcnt(0)
    v_lshlrev_b32 v240, 16, v28
    v_and_b32 v241, 0xffff0000, v28
    v_pk_mul_f32 v[240:241], v[240:241], s[56:57]
    v_cvt_pk_bf16_f32 v240, v240, v241
    v_accvgpr_write_b32 a28, v240
    v_lshlrev_b32 v242, 16, v29
    v_and_b32 v243, 0xffff0000, v29
    v_pk_mul_f32 v[242:243], v[242:243], s[56:57]
    v_cvt_pk_bf16_f32 v242, v242, v243
    v_accvgpr_write_b32 a29, v242
    v_lshlrev_b32 v240, 16, v30
    v_and_b32 v241, 0xffff0000, v30
    v_pk_mul_f32 v[240:241], v[240:241], s[56:57]
    v_cvt_pk_bf16_f32 v240, v240, v241
    v_accvgpr_write_b32 a30, v240
    v_lshlrev_b32 v242, 16, v31
    v_and_b32 v243, 0xffff0000, v31
    v_pk_mul_f32 v[242:243], v[242:243], s[56:57]
    v_cvt_pk_bf16_f32 v242, v242, v243
    v_accvgpr_write_b32 a31, v242
    s_waitcnt vmcnt(4)
    v_add_u32 v244, s55, v208
    v_add_u32 v245, s55, v209
    v_add_u32 v246, s55, v210
    v_add_u32 v247, s55, v211
    v_add_u32 v248, s55, v212
    v_add_u32 v249, s55, v213
    v_add_u32 v250, s55, v214
    v_add_u32 v251, s55, v215
    ds_read_b128 v[128:131], v244
    ds_read_b128 v[132:135], v245
    ds_read_b128 v[136:139], v246
    ds_read_b128 v[140:143], v247
    ds_read_b128 v[144:147], v248
    ds_read_b128 v[148:151], v249
    ds_read_b128 v[152:155], v250
    ds_read_b128 v[156:159], v251
    s_waitcnt lgkmcnt(7)
    v_lshlrev_b32 v240, 16, v128
    v_and_b32 v241, 0xffff0000, v128
    v_pk_mul_f32 v[240:241], v[240:241], s[56:57]
    v_cvt_pk_bf16_f32 v240, v240, v241
    v_accvgpr_write_b32 a32, v240
    v_lshlrev_b32 v242, 16, v129
    v_and_b32 v243, 0xffff0000, v129
    v_pk_mul_f32 v[242:243], v[242:243], s[56:57]
    v_cvt_pk_bf16_f32 v242, v242, v243
    v_accvgpr_write_b32 a33, v242
    v_lshlrev_b32 v240, 16, v130
    v_and_b32 v241, 0xffff0000, v130
    v_pk_mul_f32 v[240:241], v[240:241], s[56:57]
    v_cvt_pk_bf16_f32 v240, v240, v241
    v_accvgpr_write_b32 a34, v240
    v_lshlrev_b32 v242, 16, v131
    v_and_b32 v243, 0xffff0000, v131
    v_pk_mul_f32 v[242:243], v[242:243], s[56:57]
    v_cvt_pk_bf16_f32 v242, v242, v243
    v_accvgpr_write_b32 a35, v242
    s_waitcnt lgkmcnt(6)
    v_lshlrev_b32 v240, 16, v132
    v_and_b32 v241, 0xffff0000, v132
    v_pk_mul_f32 v[240:241], v[240:241], s[56:57]
    v_cvt_pk_bf16_f32 v240, v240, v241
    v_accvgpr_write_b32 a36, v240
    v_lshlrev_b32 v242, 16, v133
    v_and_b32 v243, 0xffff0000, v133
    v_pk_mul_f32 v[242:243], v[242:243], s[56:57]
    v_cvt_pk_bf16_f32 v242, v242, v243
    v_accvgpr_write_b32 a37, v242
    v_lshlrev_b32 v240, 16, v134
    v_and_b32 v241, 0xffff0000, v134
    v_pk_mul_f32 v[240:241], v[240:241], s[56:57]
    v_cvt_pk_bf16_f32 v240, v240, v241
    v_accvgpr_write_b32 a38, v240
    v_lshlrev_b32 v242, 16, v135
    v_and_b32 v243, 0xffff0000, v135
    v_pk_mul_f32 v[242:243], v[242:243], s[56:57]
    v_cvt_pk_bf16_f32 v242, v242, v243
    v_accvgpr_write_b32 a39, v242
    s_waitcnt lgkmcnt(5)
    v_lshlrev_b32 v240, 16, v136
    v_and_b32 v241, 0xffff0000, v136
    v_pk_mul_f32 v[240:241], v[240:241], s[56:57]
    v_cvt_pk_bf16_f32 v240, v240, v241
    v_accvgpr_write_b32 a40, v240
    v_lshlrev_b32 v242, 16, v137
    v_and_b32 v243, 0xffff0000, v137
    v_pk_mul_f32 v[242:243], v[242:243], s[56:57]
    v_cvt_pk_bf16_f32 v242, v242, v243
    v_accvgpr_write_b32 a41, v242
    v_lshlrev_b32 v240, 16, v138
    v_and_b32 v241, 0xffff0000, v138
    v_pk_mul_f32 v[240:241], v[240:241], s[56:57]
    v_cvt_pk_bf16_f32 v240, v240, v241
    v_accvgpr_write_b32 a42, v240
    v_lshlrev_b32 v242, 16, v139
    v_and_b32 v243, 0xffff0000, v139
    v_pk_mul_f32 v[242:243], v[242:243], s[56:57]
    v_cvt_pk_bf16_f32 v242, v242, v243
    v_accvgpr_write_b32 a43, v242
    s_waitcnt lgkmcnt(4)
    v_lshlrev_b32 v240, 16, v140
    v_and_b32 v241, 0xffff0000, v140
    v_pk_mul_f32 v[240:241], v[240:241], s[56:57]
    v_cvt_pk_bf16_f32 v240, v240, v241
    v_accvgpr_write_b32 a44, v240
    v_lshlrev_b32 v242, 16, v141
    v_and_b32 v243, 0xffff0000, v141
    v_pk_mul_f32 v[242:243], v[242:243], s[56:57]
    v_cvt_pk_bf16_f32 v242, v242, v243
    v_accvgpr_write_b32 a45, v242
    v_lshlrev_b32 v240, 16, v142
    v_and_b32 v241, 0xffff0000, v142
    v_pk_mul_f32 v[240:241], v[240:241], s[56:57]
    v_cvt_pk_bf16_f32 v240, v240, v241
    v_accvgpr_write_b32 a46, v240
    v_lshlrev_b32 v242, 16, v143
    v_and_b32 v243, 0xffff0000, v143
    v_pk_mul_f32 v[242:243], v[242:243], s[56:57]
    v_cvt_pk_bf16_f32 v242, v242, v243
    v_accvgpr_write_b32 a47, v242
    s_add_u32 m0, s50, 16384
    s_nop 0
    buffer_load_dwordx4 v220, s[20:23], s62 offen nt lds
    buffer_load_dwordx4 v221, s[20:23], s62 offen offset:1024 nt lds
    s_waitcnt lgkmcnt(3)
    v_lshlrev_b32 v240, 16, v144
    v_and_b32 v241, 0xffff0000, v144
    v_pk_mul_f32 v[240:241], v[240:241], s[56:57]
    v_cvt_pk_bf16_f32 v240, v240, v241
    v_accvgpr_write_b32 a48, v240
    v_lshlrev_b32 v242, 16, v145
    v_and_b32 v243, 0xffff0000, v145
    v_pk_mul_f32 v[242:243], v[242:243], s[56:57]
    v_cvt_pk_bf16_f32 v242, v242, v243
    v_accvgpr_write_b32 a49, v242
    v_lshlrev_b32 v240, 16, v146
    v_and_b32 v241, 0xffff0000, v146
    v_pk_mul_f32 v[240:241], v[240:241], s[56:57]
    v_cvt_pk_bf16_f32 v240, v240, v241
    v_accvgpr_write_b32 a50, v240
    v_lshlrev_b32 v242, 16, v147
    v_and_b32 v243, 0xffff0000, v147
    v_pk_mul_f32 v[242:243], v[242:243], s[56:57]
    v_cvt_pk_bf16_f32 v242, v242, v243
    v_accvgpr_write_b32 a51, v242
    s_waitcnt lgkmcnt(2)
    v_lshlrev_b32 v240, 16, v148
    v_and_b32 v241, 0xffff0000, v148
    v_pk_mul_f32 v[240:241], v[240:241], s[56:57]
    v_cvt_pk_bf16_f32 v240, v240, v241
    v_accvgpr_write_b32 a52, v240
    v_lshlrev_b32 v242, 16, v149
    v_and_b32 v243, 0xffff0000, v149
    v_pk_mul_f32 v[242:243], v[242:243], s[56:57]
    v_cvt_pk_bf16_f32 v242, v242, v243
    v_accvgpr_write_b32 a53, v242
    v_lshlrev_b32 v240, 16, v150
    v_and_b32 v241, 0xffff0000, v150
    v_pk_mul_f32 v[240:241], v[240:241], s[56:57]
    v_cvt_pk_bf16_f32 v240, v240, v241
    v_accvgpr_write_b32 a54, v240
    v_lshlrev_b32 v242, 16, v151
    v_and_b32 v243, 0xffff0000, v151
    v_pk_mul_f32 v[242:243], v[242:243], s[56:57]
    v_cvt_pk_bf16_f32 v242, v242, v243
    v_accvgpr_write_b32 a55, v242
    s_waitcnt lgkmcnt(1)
    v_lshlrev_b32 v240, 16, v152
    v_and_b32 v241, 0xffff0000, v152
    v_pk_mul_f32 v[240:241], v[240:241], s[56:57]
    v_cvt_pk_bf16_f32 v240, v240, v241
    v_accvgpr_write_b32 a56, v240
    v_lshlrev_b32 v242, 16, v153
    v_and_b32 v243, 0xffff0000, v153
    v_pk_mul_f32 v[242:243], v[242:243], s[56:57]
    v_cvt_pk_bf16_f32 v242, v242, v243
    v_accvgpr_write_b32 a57, v242
    v_lshlrev_b32 v240, 16, v154
    v_and_b32 v241, 0xffff0000, v154
    v_pk_mul_f32 v[240:241], v[240:241], s[56:57]
    v_cvt_pk_bf16_f32 v240, v240, v241
    v_accvgpr_write_b32 a58, v240
    v_lshlrev_b32 v242, 16, v155
    v_and_b32 v243, 0xffff0000, v155
    v_pk_mul_f32 v[242:243], v[242:243], s[56:57]
    v_cvt_pk_bf16_f32 v242, v242, v243
    v_accvgpr_write_b32 a59, v242
    s_waitcnt lgkmcnt(0)
    v_lshlrev_b32 v240, 16, v156
    v_and_b32 v241, 0xffff0000, v156
    v_pk_mul_f32 v[240:241], v[240:241], s[56:57]
    v_cvt_pk_bf16_f32 v240, v240, v241
    v_accvgpr_write_b32 a60, v240
    v_lshlrev_b32 v242, 16, v157
    v_and_b32 v243, 0xffff0000, v157
    v_pk_mul_f32 v[242:243], v[242:243], s[56:57]
    v_cvt_pk_bf16_f32 v242, v242, v243
    v_accvgpr_write_b32 a61, v242
    v_lshlrev_b32 v240, 16, v158
    v_and_b32 v241, 0xffff0000, v158
    v_pk_mul_f32 v[240:241], v[240:241], s[56:57]
    v_cvt_pk_bf16_f32 v240, v240, v241
    v_accvgpr_write_b32 a62, v240
    v_lshlrev_b32 v242, 16, v159
    v_and_b32 v243, 0xffff0000, v159
    v_pk_mul_f32 v[242:243], v[242:243], s[56:57]
    v_cvt_pk_bf16_f32 v242, v242, v243
    v_accvgpr_write_b32 a63, v242
    s_add_u32 m0, s51, 8192
    s_nop 0
    buffer_load_dwordx4 v222, s[24:27], s61 offen nt lds
    buffer_load_dwordx4 v223, s[24:27], s61 offen offset:1024 nt lds
    s_waitcnt vmcnt(16)
    s_barrier
    ds_read_b128 a[64:67], v208 offset:0
    ds_read_b128 a[68:71], v209 offset:0
    ds_read_b128 a[72:75], v210 offset:0
    ds_read_b128 a[76:79], v211 offset:0
    ds_read_b128 a[80:83], v212 offset:0
    ds_read_b128 a[84:87], v213 offset:0
    ds_read_b128 a[88:91], v214 offset:0
    ds_read_b128 a[92:95], v215 offset:0
    s_waitcnt lgkmcnt(7)
    v_mfma_f32_32x32x16_bf16 v[0:15], a[64:67], a[0:3], v[32:47]
    v_mov_b32 v128, 0
    v_mov_b32 v129, 0
    v_mov_b32 v130, 0
    v_mov_b32 v131, 0
    s_waitcnt lgkmcnt(6)
    v_mfma_f32_32x32x16_bf16 v[0:15], a[68:71], a[4:7], v[0:15]
    v_mov_b32 v132, 0
    v_mov_b32 v133, 0
    v_mov_b32 v134, 0
    v_mov_b32 v135, 0
    s_waitcnt lgkmcnt(5)
    v_mfma_f32_32x32x16_bf16 v[0:15], a[72:75], a[8:11], v[0:15]
    v_mov_b32 v136, 0
    v_mov_b32 v137, 0
    v_mov_b32 v138, 0
    v_mov_b32 v139, 0
    s_waitcnt lgkmcnt(4)
    v_mfma_f32_32x32x16_bf16 v[0:15], a[76:79], a[12:15], v[0:15]
    v_mov_b32 v140, 0
    v_mov_b32 v141, 0
    v_mov_b32 v142, 0
    v_mov_b32 v143, 0
    s_waitcnt lgkmcnt(3)
    v_mfma_f32_32x32x16_bf16 v[0:15], a[80:83], a[16:19], v[0:15]
    v_mov_b32 v144, 0
    v_mov_b32 v145, 0
    v_mov_b32 v146, 0
    v_mov_b32 v147, 0
    s_waitcnt lgkmcnt(2)
    v_mfma_f32_32x32x16_bf16 v[0:15], a[84:87], a[20:23], v[0:15]
    v_mov_b32 v148, 0
    v_mov_b32 v149, 0
    v_mov_b32 v150, 0
    v_mov_b32 v151, 0
    s_waitcnt lgkmcnt(1)
    v_mfma_f32_32x32x16_bf16 v[0:15], a[88:91], a[24:27], v[0:15]
    v_mov_b32 v152, 0
    v_mov_b32 v153, 0
    v_mov_b32 v154, 0
    v_mov_b32 v155, 0
    s_waitcnt lgkmcnt(0)
    v_mfma_f32_32x32x16_bf16 v[0:15], a[92:95], a[28:31], v[0:15]
    v_mov_b32 v156, 0
    v_mov_b32 v157, 0
    v_mov_b32 v158, 0
    v_mov_b32 v159, 0
    v_mfma_f32_32x32x16_bf16 v[16:31], a[64:67], a[32:35], v[48:63]
    s_nop 7
    v_mfma_f32_32x32x16_bf16 v[16:31], a[68:71], a[36:39], v[16:31]
    v_max3_f32 v227, v0, v1, v2
    v_max3_f32 v227, v227, v3, v4
    v_max3_f32 v227, v227, v5, v6
    v_max3_f32 v227, v227, v7, v8
    v_max3_f32 v227, v227, v9, v10
    v_mfma_f32_32x32x16_bf16 v[16:31], a[72:75], a[40:43], v[16:31]
    v_max3_f32 v227, v227, v11, v12
    v_max3_f32 v227, v227, v13, v14
    v_max_f32 v227, v227, v15
    v_mov_b32 v240, v227
    s_nop 1
    v_mfma_f32_32x32x16_bf16 v[16:31], a[76:79], a[44:47], v[16:31]
    v_permlane32_swap_b32 v227, v240
    s_nop 1
    v_max_f32 v227, v227, v240
    v_sub_f32 v0, v0, v227
    v_sub_f32 v1, v1, v227
    v_mfma_f32_32x32x16_bf16 v[16:31], a[80:83], a[48:51], v[16:31]
    v_sub_f32 v2, v2, v227
    v_sub_f32 v3, v3, v227
    v_sub_f32 v4, v4, v227
    v_sub_f32 v5, v5, v227
    v_sub_f32 v6, v6, v227
    v_mfma_f32_32x32x16_bf16 v[16:31], a[84:87], a[52:55], v[16:31]
    v_sub_f32 v7, v7, v227
    v_sub_f32 v8, v8, v227
    v_sub_f32 v9, v9, v227
    v_sub_f32 v10, v10, v227
    v_sub_f32 v11, v11, v227
    v_mfma_f32_32x32x16_bf16 v[16:31], a[88:91], a[56:59], v[16:31]
    v_sub_f32 v12, v12, v227
    v_sub_f32 v13, v13, v227
    v_sub_f32 v14, v14, v227
    v_sub_f32 v15, v15, v227
    v_sub_f32 v32, v32, v227
    v_mfma_f32_32x32x16_bf16 v[16:31], a[92:95], a[60:63], v[16:31]
    v_sub_f32 v33, v33, v227
    v_sub_f32 v34, v34, v227
    v_sub_f32 v35, v35, v227
    v_sub_f32 v36, v36, v227
    v_sub_f32 v37, v37, v227
    s_mov_b32 s48, s68
    v_sub_f32 v38, v38, v227
    v_sub_f32 v39, v39, v227
    v_sub_f32 v40, v40, v227
    v_sub_f32 v41, v41, v227
    v_sub_f32 v42, v42, v227
    v_sub_f32 v43, v43, v227
    v_sub_f32 v44, v44, v227
    v_sub_f32 v45, v45, v227
    v_sub_f32 v46, v46, v227
    v_sub_f32 v47, v47, v227
    s_nop 7
    v_max3_f32 v228, v16, v17, v18
    v_max3_f32 v228, v228, v19, v20
    v_max3_f32 v228, v228, v21, v22
    v_max3_f32 v228, v228, v23, v24
    v_max3_f32 v228, v228, v25, v26
    v_max3_f32 v228, v228, v27, v28
    v_max3_f32 v228, v228, v29, v30
    v_max_f32 v228, v228, v31
    v_mov_b32 v240, v228
    s_nop 1
    v_permlane32_swap_b32 v228, v240
    s_nop 1
    v_max_f32 v228, v228, v240
    v_sub_f32 v48, v48, v228
    v_sub_f32 v49, v49, v228
    v_sub_f32 v50, v50, v228
    v_sub_f32 v51, v51, v228
    v_sub_f32 v52, v52, v228
    v_sub_f32 v53, v53, v228
    v_sub_f32 v54, v54, v228
    v_sub_f32 v55, v55, v228
    v_sub_f32 v56, v56, v228
    v_sub_f32 v57, v57, v228
    v_sub_f32 v58, v58, v228
    v_sub_f32 v59, v59, v228
    v_sub_f32 v60, v60, v228
    v_sub_f32 v61, v61, v228
    v_sub_f32 v62, v62, v228
    v_sub_f32 v63, v63, v228
    s_cmp_eq_u32 s40, 0
    s_cselect_b32 s74, 0, 0x80000000
    buffer_load_dwordx2 v[250:251], off, s[32:35], s74 sc1

    v_exp_f32 v229, v0
    v_exp_f32 v230, v1
    s_nop 1
L_body_p0:
    s_waitcnt vmcnt(0)
    s_barrier
    v_mfma_f32_32x32x16_bf16 v[16:31], a[64:67], a[32:35], v[48:63]
    v_exp_f32 v233, v2
    v_cvt_pk_bf16_f32 v192, v229, v230
    v_exp_f32 v234, v3
    v_add_f32 v229, v229, v233
    v_mfma_f32_32x32x16_bf16 v[16:31], a[68:71], a[36:39], v[16:31]
    ds_read_b128 a[64:67], v208 offset:8192
    v_exp_f32 v235, v4
    v_add_f32 v230, v230, v234
    v_cvt_pk_bf16_f32 v193, v233, v234
    v_mfma_f32_32x32x16_bf16 v[16:31], a[72:75], a[40:43], v[16:31]
    ds_read_b128 a[68:71], v209 offset:8192
    v_exp_f32 v236, v5
    v_add_f32 v229, v229, v235
    v_mfma_f32_32x32x16_bf16 v[16:31], a[76:79], a[44:47], v[16:31]
    ds_read_b128 a[72:75], v210 offset:8192
    v_exp_f32 v237, v6
    v_add_f32 v230, v230, v236
    v_cvt_pk_bf16_f32 v194, v235, v236
    v_mfma_f32_32x32x16_bf16 v[16:31], a[80:83], a[48:51], v[16:31]
    ds_read_b128 a[76:79], v211 offset:8192
    v_exp_f32 v238, v7
    v_add_f32 v229, v229, v237
    v_exp_f32 v233, v8
    v_mfma_f32_32x32x16_bf16 v[16:31], a[84:87], a[52:55], v[16:31]
    ds_read_b128 a[80:83], v212 offset:8192
    v_add_f32 v230, v230, v238
    v_cvt_pk_bf16_f32 v195, v237, v238
    v_exp_f32 v234, v9
    v_mfma_f32_32x32x16_bf16 v[16:31], a[88:91], a[56:59], v[16:31]
    ds_read_b128 a[84:87], v213 offset:8192
    v_add_f32 v229, v229, v233
    v_exp_f32 v235, v10
    v_add_f32 v230, v230, v234
    v_mfma_f32_32x32x16_bf16 v[16:31], a[92:95], a[60:63], v[16:31]
    ds_read_b128 a[88:91], v214 offset:8192
    v_cvt_pk_bf16_f32 v196, v233, v234
    v_exp_f32 v236, v11
    v_add_f32 v229, v229, v235
    v_mfma_f32_32x32x16_bf16 v[128:143], a[96:99], v[200:203], v[128:143]
    ds_read_b128 a[92:95], v215 offset:8192
    v_exp_f32 v237, v12
    v_add_f32 v230, v230, v236
    v_cvt_pk_bf16_f32 v197, v235, v236
    s_cmp_eq_u32 s44, s45
    v_mfma_f32_32x32x16_bf16 v[144:159], a[100:103], v[200:203], v[144:159]
    s_cbranch_scc1 L_patch_p0
L_patch_ret_p0:
    ds_read_b64_tr_b16 a[96:97], v216 offset:0
    v_exp_f32 v238, v13
    v_mfma_f32_32x32x16_bf16 v[160:175], a[104:107], v[200:203], v[160:175]
    ds_read_b64_tr_b16 a[98:99], v216 offset:2048
    v_add_f32 v229, v229, v237
    v_exp_f32 v233, v14
    v_add_f32 v230, v230, v238
    v_mfma_f32_32x32x16_bf16 v[176:191], a[108:111], v[200:203], v[176:191]
    ds_read_b64_tr_b16 a[100:101], v217 offset:0
    v_cvt_pk_bf16_f32 v198, v237, v238
    v_exp_f32 v234, v15
    v_add_f32 v229, v229, v233
    v_mfma_f32_32x32x16_bf16 v[128:143], a[112:115], v[204:207], v[128:143]
    ds_read_b64_tr_b16 a[102:103], v217 offset:2048
    v_add_f32 v230, v230, v234
    v_cvt_pk_bf16_f32 v199, v233, v234
    v_add_f32 v229, v229, v230
    v_cmp_lt_f32 vcc, s52, v229
    v_mfma_f32_32x32x16_bf16 v[144:159], a[116:119], v[204:207], v[144:159]
    ds_read_b64_tr_b16 a[104:105], v218 offset:0
    v_exp_f32 v231, v16
    v_exp_f32 v232, v17
    v_mfma_f32_32x32x16_bf16 v[160:175], a[120:123], v[204:207], v[160:175]
    s_cbranch_vccnz L_fb0_p0
L_fb0_ret_p0:
    ds_read_b64_tr_b16 a[106:107], v218 offset:2048
    v_add_f32 v225, v225, v229
    v_exp_f32 v233, v18
    v_mfma_f32_32x32x16_bf16 v[176:191], a[124:127], v[204:207], v[176:191]
    ds_read_b64_tr_b16 a[108:109], v219 offset:0
    v_cvt_pk_bf16_f32 v200, v231, v232
    v_exp_f32 v234, v19
    s_waitcnt lgkmcnt(7)
    v_mfma_f32_32x32x16_bf16 v[0:15], a[64:67], a[0:3], v[32:47]
    ds_read_b64_tr_b16 a[110:111], v219 offset:2048
    v_add_f32 v231, v231, v233
    v_exp_f32 v235, v20
    v_add_f32 v232, v232, v234
    v_mfma_f32_32x32x16_bf16 v[0:15], a[68:71], a[4:7], v[0:15]
    ds_read_b64_tr_b16 a[112:113], v216 offset:4096
    v_cvt_pk_bf16_f32 v201, v233, v234
    v_exp_f32 v236, v21
    v_add_f32 v231, v231, v235
    v_mfma_f32_32x32x16_bf16 v[0:15], a[72:75], a[8:11], v[0:15]
    ds_read_b64_tr_b16 a[114:115], v216 offset:6144
    v_exp_f32 v237, v22
    v_add_f32 v232, v232, v236
    v_cvt_pk_bf16_f32 v202, v235, v236
    s_add_u32 m0, s50, 24576
    v_mfma_f32_32x32x16_bf16 v[0:15], a[76:79], a[12:15], v[0:15]
    ds_read_b64_tr_b16 a[116:117], v217 offset:4096
    buffer_load_dwordx4 v220, s[20:23], s63 offen nt lds
    v_exp_f32 v238, v23
    v_add_f32 v231, v231, v237
    v_exp_f32 v233, v24
    v_mfma_f32_32x32x16_bf16 v[0:15], a[80:83], a[16:19], v[0:15]
    ds_read_b64_tr_b16 a[118:119], v217 offset:6144
    buffer_load_dwordx4 v221, s[20:23], s63 offen offset:1024 nt lds
    v_add_f32 v232, v232, v238
    v_cvt_pk_bf16_f32 v203, v237, v238
    v_exp_f32 v234, v25
    v_mfma_f32_32x32x16_bf16 v[0:15], a[84:87], a[20:23], v[0:15]
    ds_read_b64_tr_b16 a[120:121], v218 offset:4096
    v_add_f32 v231, v231, v233
    v_exp_f32 v235, v26
    s_add_u32 m0, s51, 16384
    v_mfma_f32_32x32x16_bf16 v[0:15], a[88:91], a[24:27], v[0:15]
    ds_read_b64_tr_b16 a[122:123], v218 offset:6144
    buffer_load_dwordx4 v222, s[24:27], s62 offen nt lds
    v_add_f32 v232, v232, v234
    v_cvt_pk_bf16_f32 v204, v233, v234
    v_exp_f32 v236, v27
    v_mfma_f32_32x32x16_bf16 v[0:15], a[92:95], a[28:31], v[0:15]
    ds_read_b64_tr_b16 a[124:125], v219 offset:4096
    buffer_load_dwordx4 v223, s[24:27], s62 offen offset:1024 nt lds
    v_add_f32 v231, v231, v235
    v_exp_f32 v237, v28
    s_waitcnt lgkmcnt(7)
    v_mfma_f32_32x32x16_bf16 v[64:79], a[96:99], v[192:195], v[64:79]
    ds_read_b64_tr_b16 a[126:127], v219 offset:6144
    v_add_f32 v232, v232, v236
    v_cvt_pk_bf16_f32 v205, v235, v236
    v_exp_f32 v238, v29
    s_add_u32 m0, s50, 32768
    v_mfma_f32_32x32x16_bf16 v[80:95], a[100:103], v[192:195], v[80:95]
    buffer_load_dwordx4 v220, s[20:23], s64 offen nt lds
    v_add_f32 v231, v231, v237
    v_exp_f32 v233, v30
    v_mfma_f32_32x32x16_bf16 v[96:111], a[104:107], v[192:195], v[96:111]
    buffer_load_dwordx4 v221, s[20:23], s64 offen offset:1024 nt lds
    v_add_f32 v232, v232, v238
    v_cvt_pk_bf16_f32 v206, v237, v238
    s_add_u32 m0, s51, 24576
    v_mfma_f32_32x32x16_bf16 v[112:127], a[108:111], v[192:195], v[112:127]
    buffer_load_dwordx4 v222, s[24:27], s63 offen nt lds
    v_exp_f32 v234, v31
    s_waitcnt lgkmcnt(0)
    v_mfma_f32_32x32x16_bf16 v[64:79], a[112:115], v[196:199], v[64:79]
    buffer_load_dwordx4 v223, s[24:27], s63 offen offset:1024 nt lds
    v_add_f32 v231, v231, v233
    v_add_f32 v232, v232, v234
    v_cvt_pk_bf16_f32 v207, v233, v234
    v_add_f32 v231, v231, v232
    v_cmp_lt_f32 vcc, s52, v231
    v_mfma_f32_32x32x16_bf16 v[80:95], a[116:119], v[196:199], v[80:95]
    v_exp_f32 v229, v0
    v_mfma_f32_32x32x16_bf16 v[96:111], a[120:123], v[196:199], v[96:111]
    s_cbranch_vccnz L_fb1_p0
L_fb1_ret_p0:
    v_add_f32 v226, v226, v231
    v_exp_f32 v230, v1
    s_add_u32 s44, s44, 1
    s_cmp_ge_u32 s44, s43
    v_mfma_f32_32x32x16_bf16 v[112:127], a[124:127], v[196:199], v[112:127]
    s_cbranch_scc1 L_drain
L_body_p1:
    v_mfma_f32_32x32x16_bf16 v[16:31], a[64:67], a[32:35], v[48:63]
    v_exp_f32 v233, v2
    v_cvt_pk_bf16_f32 v192, v229, v230
    v_exp_f32 v234, v3
    v_add_f32 v229, v229, v233
    v_mfma_f32_32x32x16_bf16 v[16:31], a[68:71], a[36:39], v[16:31]
    ds_read_b128 a[64:67], v208 offset:16384
    v_exp_f32 v235, v4
    v_add_f32 v230, v230, v234
    v_cvt_pk_bf16_f32 v193, v233, v234
    v_mfma_f32_32x32x16_bf16 v[16:31], a[72:75], a[40:43], v[16:31]
    ds_read_b128 a[68:71], v209 offset:16384
    v_exp_f32 v236, v5
    v_add_f32 v229, v229, v235
    v_mfma_f32_32x32x16_bf16 v[16:31], a[76:79], a[44:47], v[16:31]
    ds_read_b128 a[72:75], v210 offset:16384
    v_exp_f32 v237, v6
    v_add_f32 v230, v230, v236
    v_cvt_pk_bf16_f32 v194, v235, v236
    v_mfma_f32_32x32x16_bf16 v[16:31], a[80:83], a[48:51], v[16:31]
    ds_read_b128 a[76:79], v211 offset:16384
    v_exp_f32 v238, v7
    v_add_f32 v229, v229, v237
    v_exp_f32 v233, v8
    v_mfma_f32_32x32x16_bf16 v[16:31], a[84:87], a[52:55], v[16:31]
    ds_read_b128 a[80:83], v212 offset:16384
    v_add_f32 v230, v230, v238
    v_cvt_pk_bf16_f32 v195, v237, v238
    v_exp_f32 v234, v9
    v_mfma_f32_32x32x16_bf16 v[16:31], a[88:91], a[56:59], v[16:31]
    ds_read_b128 a[84:87], v213 offset:16384
    v_add_f32 v229, v229, v233
    v_exp_f32 v235, v10
    v_add_f32 v230, v230, v234
    v_mfma_f32_32x32x16_bf16 v[16:31], a[92:95], a[60:63], v[16:31]
    ds_read_b128 a[88:91], v214 offset:16384
    v_cvt_pk_bf16_f32 v196, v233, v234
    v_exp_f32 v236, v11
    v_add_f32 v229, v229, v235
    v_mfma_f32_32x32x16_bf16 v[128:143], a[96:99], v[200:203], v[128:143]
    ds_read_b128 a[92:95], v215 offset:16384
    v_exp_f32 v237, v12
    v_add_f32 v230, v230, v236
    v_cvt_pk_bf16_f32 v197, v235, v236
    s_cmp_eq_u32 s44, s45
    v_mfma_f32_32x32x16_bf16 v[144:159], a[100:103], v[200:203], v[144:159]
    s_cbranch_scc1 L_patch_p1
L_patch_ret_p1:
    ds_read_b64_tr_b16 a[96:97], v216 offset:8192
    v_exp_f32 v238, v13
    v_mfma_f32_32x32x16_bf16 v[160:175], a[104:107], v[200:203], v[160:175]
    ds_read_b64_tr_b16 a[98:99], v216 offset:10240
    v_add_f32 v229, v229, v237
    v_exp_f32 v233, v14
    v_add_f32 v230, v230, v238
    v_mfma_f32_32x32x16_bf16 v[176:191], a[108:111], v[200:203], v[176:191]
    ds_read_b64_tr_b16 a[100:101], v217 offset:8192
    v_cvt_pk_bf16_f32 v198, v237, v238
    v_exp_f32 v234, v15
    v_add_f32 v229, v229, v233
    v_mfma_f32_32x32x16_bf16 v[128:143], a[112:115], v[204:207], v[128:143]
    ds_read_b64_tr_b16 a[102:103], v217 offset:10240
    v_add_f32 v230, v230, v234
    v_cvt_pk_bf16_f32 v199, v233, v234
    v_add_f32 v229, v229, v230
    v_cmp_lt_f32 vcc, s52, v229
    v_mfma_f32_32x32x16_bf16 v[144:159], a[116:119], v[204:207], v[144:159]
    ds_read_b64_tr_b16 a[104:105], v218 offset:8192
    v_exp_f32 v231, v16
    v_exp_f32 v232, v17
    v_mfma_f32_32x32x16_bf16 v[160:175], a[120:123], v[204:207], v[160:175]
    s_cbranch_vccnz L_fb0_p1
L_fb0_ret_p1:
    ds_read_b64_tr_b16 a[106:107], v218 offset:10240
    v_add_f32 v225, v225, v229
    v_exp_f32 v233, v18
    v_mfma_f32_32x32x16_bf16 v[176:191], a[124:127], v[204:207], v[176:191]
    ds_read_b64_tr_b16 a[108:109], v219 offset:8192
    v_cvt_pk_bf16_f32 v200, v231, v232
    v_exp_f32 v234, v19
    s_waitcnt lgkmcnt(7)
    v_mfma_f32_32x32x16_bf16 v[0:15], a[64:67], a[0:3], v[32:47]
    ds_read_b64_tr_b16 a[110:111], v219 offset:10240
    v_add_f32 v231, v231, v233
    v_exp_f32 v235, v20
    v_add_f32 v232, v232, v234
    v_mfma_f32_32x32x16_bf16 v[0:15], a[68:71], a[4:7], v[0:15]
    ds_read_b64_tr_b16 a[112:113], v216 offset:12288
    v_cvt_pk_bf16_f32 v201, v233, v234
    v_exp_f32 v236, v21
    v_add_f32 v231, v231, v235
    v_mfma_f32_32x32x16_bf16 v[0:15], a[72:75], a[8:11], v[0:15]
    ds_read_b64_tr_b16 a[114:115], v216 offset:14336
    v_exp_f32 v237, v22
    v_add_f32 v232, v232, v236
    v_cvt_pk_bf16_f32 v202, v235, v236
    s_add_u32 m0, s50, 40960
    v_mfma_f32_32x32x16_bf16 v[0:15], a[76:79], a[12:15], v[0:15]
    ds_read_b64_tr_b16 a[116:117], v217 offset:12288
    buffer_load_dwordx4 v220, s[20:23], s65 offen nt lds
    v_exp_f32 v238, v23
    v_add_f32 v231, v231, v237
    v_exp_f32 v233, v24
    v_mfma_f32_32x32x16_bf16 v[0:15], a[80:83], a[16:19], v[0:15]
    ds_read_b64_tr_b16 a[118:119], v217 offset:14336
    buffer_load_dwordx4 v221, s[20:23], s65 offen offset:1024 nt lds
    v_add_f32 v232, v232, v238
    v_cvt_pk_bf16_f32 v203, v237, v238
    v_exp_f32 v234, v25
    v_mfma_f32_32x32x16_bf16 v[0:15], a[84:87], a[20:23], v[0:15]
    ds_read_b64_tr_b16 a[120:121], v218 offset:12288
    v_add_f32 v231, v231, v233
    v_exp_f32 v235, v26
    s_add_u32 m0, s51, 32768
    v_mfma_f32_32x32x16_bf16 v[0:15], a[88:91], a[24:27], v[0:15]
    ds_read_b64_tr_b16 a[122:123], v218 offset:14336
    buffer_load_dwordx4 v222, s[24:27], s64 offen nt lds
    v_add_f32 v232, v232, v234
    v_cvt_pk_bf16_f32 v204, v233, v234
    v_exp_f32 v236, v27
    v_mfma_f32_32x32x16_bf16 v[0:15], a[92:95], a[28:31], v[0:15]
    ds_read_b64_tr_b16 a[124:125], v219 offset:12288
    buffer_load_dwordx4 v223, s[24:27], s64 offen offset:1024 nt lds
    v_add_f32 v231, v231, v235
    v_exp_f32 v237, v28
    s_waitcnt lgkmcnt(7)
    v_mfma_f32_32x32x16_bf16 v[64:79], a[96:99], v[192:195], v[64:79]
    ds_read_b64_tr_b16 a[126:127], v219 offset:14336
    v_add_f32 v232, v232, v236
    v_cvt_pk_bf16_f32 v205, v235, v236
    v_exp_f32 v238, v29
    s_add_u32 m0, s50, 49152
    v_mfma_f32_32x32x16_bf16 v[80:95], a[100:103], v[192:195], v[80:95]
    buffer_load_dwordx4 v220, s[20:23], s66 offen nt lds
    v_add_f32 v231, v231, v237
    v_exp_f32 v233, v30
    v_mfma_f32_32x32x16_bf16 v[96:111], a[104:107], v[192:195], v[96:111]
    buffer_load_dwordx4 v221, s[20:23], s66 offen offset:1024 nt lds
    v_add_f32 v232, v232, v238
    v_cvt_pk_bf16_f32 v206, v237, v238
    s_add_u32 m0, s51, 40960
    v_mfma_f32_32x32x16_bf16 v[112:127], a[108:111], v[192:195], v[112:127]
    buffer_load_dwordx4 v222, s[24:27], s65 offen nt lds
    v_exp_f32 v234, v31
    s_waitcnt lgkmcnt(0)
    v_mfma_f32_32x32x16_bf16 v[64:79], a[112:115], v[196:199], v[64:79]
    buffer_load_dwordx4 v223, s[24:27], s65 offen offset:1024 nt lds
    v_add_f32 v231, v231, v233
    v_add_f32 v232, v232, v234
    v_cvt_pk_bf16_f32 v207, v233, v234
    v_add_f32 v231, v231, v232
    v_cmp_lt_f32 vcc, s52, v231
    v_mfma_f32_32x32x16_bf16 v[80:95], a[116:119], v[196:199], v[80:95]
    v_exp_f32 v229, v0
    v_mfma_f32_32x32x16_bf16 v[96:111], a[120:123], v[196:199], v[96:111]
    s_cbranch_vccnz L_fb1_p1
L_fb1_ret_p1:
    v_add_f32 v226, v226, v231
    v_exp_f32 v230, v1
    s_add_u32 s44, s44, 1
    s_cmp_ge_u32 s44, s43
    v_mfma_f32_32x32x16_bf16 v[112:127], a[124:127], v[196:199], v[112:127]
    s_cbranch_scc1 L_drain
L_body_p2:
    s_waitcnt vmcnt(8)
    s_barrier
    v_mfma_f32_32x32x16_bf16 v[16:31], a[64:67], a[32:35], v[48:63]
    v_exp_f32 v233, v2
    v_cvt_pk_bf16_f32 v192, v229, v230
    v_exp_f32 v234, v3
    v_add_f32 v229, v229, v233
    v_mfma_f32_32x32x16_bf16 v[16:31], a[68:71], a[36:39], v[16:31]
    ds_read_b128 a[64:67], v208 offset:24576
    v_exp_f32 v235, v4
    v_add_f32 v230, v230, v234
    v_cvt_pk_bf16_f32 v193, v233, v234
    v_mfma_f32_32x32x16_bf16 v[16:31], a[72:75], a[40:43], v[16:31]
    ds_read_b128 a[68:71], v209 offset:24576
    v_exp_f32 v236, v5
    v_add_f32 v229, v229, v235
    v_mfma_f32_32x32x16_bf16 v[16:31], a[76:79], a[44:47], v[16:31]
    ds_read_b128 a[72:75], v210 offset:24576
    v_exp_f32 v237, v6
    v_add_f32 v230, v230, v236
    v_cvt_pk_bf16_f32 v194, v235, v236
    v_mfma_f32_32x32x16_bf16 v[16:31], a[80:83], a[48:51], v[16:31]
    ds_read_b128 a[76:79], v211 offset:24576
    v_exp_f32 v238, v7
    v_add_f32 v229, v229, v237
    v_exp_f32 v233, v8
    v_mfma_f32_32x32x16_bf16 v[16:31], a[84:87], a[52:55], v[16:31]
    ds_read_b128 a[80:83], v212 offset:24576
    v_add_f32 v230, v230, v238
    v_cvt_pk_bf16_f32 v195, v237, v238
    v_exp_f32 v234, v9
    v_mfma_f32_32x32x16_bf16 v[16:31], a[88:91], a[56:59], v[16:31]
    ds_read_b128 a[84:87], v213 offset:24576
    v_add_f32 v229, v229, v233
    v_exp_f32 v235, v10
    v_add_f32 v230, v230, v234
    v_mfma_f32_32x32x16_bf16 v[16:31], a[92:95], a[60:63], v[16:31]
    ds_read_b128 a[88:91], v214 offset:24576
    v_cvt_pk_bf16_f32 v196, v233, v234
    v_exp_f32 v236, v11
    v_add_f32 v229, v229, v235
    v_mfma_f32_32x32x16_bf16 v[128:143], a[96:99], v[200:203], v[128:143]
    ds_read_b128 a[92:95], v215 offset:24576
    v_exp_f32 v237, v12
    v_add_f32 v230, v230, v236
    v_cvt_pk_bf16_f32 v197, v235, v236
    s_cmp_eq_u32 s44, s45
    v_mfma_f32_32x32x16_bf16 v[144:159], a[100:103], v[200:203], v[144:159]
    s_cbranch_scc1 L_patch_p2
L_patch_ret_p2:
    ds_read_b64_tr_b16 a[96:97], v216 offset:16384
    v_exp_f32 v238, v13
    v_mfma_f32_32x32x16_bf16 v[160:175], a[104:107], v[200:203], v[160:175]
    ds_read_b64_tr_b16 a[98:99], v216 offset:18432
    v_add_f32 v229, v229, v237
    v_exp_f32 v233, v14
    v_add_f32 v230, v230, v238
    v_mfma_f32_32x32x16_bf16 v[176:191], a[108:111], v[200:203], v[176:191]
    ds_read_b64_tr_b16 a[100:101], v217 offset:16384
    v_cvt_pk_bf16_f32 v198, v237, v238
    v_exp_f32 v234, v15
    v_add_f32 v229, v229, v233
    v_mfma_f32_32x32x16_bf16 v[128:143], a[112:115], v[204:207], v[128:143]
    ds_read_b64_tr_b16 a[102:103], v217 offset:18432
    v_add_f32 v230, v230, v234
    v_cvt_pk_bf16_f32 v199, v233, v234
    v_add_f32 v229, v229, v230
    v_cmp_lt_f32 vcc, s52, v229
    v_mfma_f32_32x32x16_bf16 v[144:159], a[116:119], v[204:207], v[144:159]
    ds_read_b64_tr_b16 a[104:105], v218 offset:16384
    v_exp_f32 v231, v16
    v_exp_f32 v232, v17
    v_mfma_f32_32x32x16_bf16 v[160:175], a[120:123], v[204:207], v[160:175]
    s_cbranch_vccnz L_fb0_p2
L_fb0_ret_p2:
    ds_read_b64_tr_b16 a[106:107], v218 offset:18432
    v_add_f32 v225, v225, v229
    v_exp_f32 v233, v18
    v_mfma_f32_32x32x16_bf16 v[176:191], a[124:127], v[204:207], v[176:191]
    ds_read_b64_tr_b16 a[108:109], v219 offset:16384
    v_cvt_pk_bf16_f32 v200, v231, v232
    v_exp_f32 v234, v19
    s_waitcnt lgkmcnt(7)
    v_mfma_f32_32x32x16_bf16 v[0:15], a[64:67], a[0:3], v[32:47]
    ds_read_b64_tr_b16 a[110:111], v219 offset:18432
    v_add_f32 v231, v231, v233
    v_exp_f32 v235, v20
    v_add_f32 v232, v232, v234
    v_mfma_f32_32x32x16_bf16 v[0:15], a[68:71], a[4:7], v[0:15]
    ds_read_b64_tr_b16 a[112:113], v216 offset:20480
    v_cvt_pk_bf16_f32 v201, v233, v234
    v_exp_f32 v236, v21
    v_add_f32 v231, v231, v235
    v_mfma_f32_32x32x16_bf16 v[0:15], a[72:75], a[8:11], v[0:15]
    ds_read_b64_tr_b16 a[114:115], v216 offset:22528
    v_exp_f32 v237, v22
    v_add_f32 v232, v232, v236
    v_cvt_pk_bf16_f32 v202, v235, v236
    s_add_u32 m0, s50, 57344
    v_mfma_f32_32x32x16_bf16 v[0:15], a[76:79], a[12:15], v[0:15]
    ds_read_b64_tr_b16 a[116:117], v217 offset:20480
    buffer_load_dwordx4 v220, s[20:23], s67 offen nt lds
    v_exp_f32 v238, v23
    v_add_f32 v231, v231, v237
    v_exp_f32 v233, v24
    v_mfma_f32_32x32x16_bf16 v[0:15], a[80:83], a[16:19], v[0:15]
    ds_read_b64_tr_b16 a[118:119], v217 offset:22528
    buffer_load_dwordx4 v221, s[20:23], s67 offen offset:1024 nt lds
    v_add_f32 v232, v232, v238
    v_cvt_pk_bf16_f32 v203, v237, v238
    v_exp_f32 v234, v25
    v_mfma_f32_32x32x16_bf16 v[0:15], a[84:87], a[20:23], v[0:15]
    ds_read_b64_tr_b16 a[120:121], v218 offset:20480
    v_add_f32 v231, v231, v233
    v_exp_f32 v235, v26
    s_add_u32 m0, s51, 49152
    v_mfma_f32_32x32x16_bf16 v[0:15], a[88:91], a[24:27], v[0:15]
    ds_read_b64_tr_b16 a[122:123], v218 offset:22528
    buffer_load_dwordx4 v222, s[24:27], s66 offen nt lds
    v_add_f32 v232, v232, v234
    v_cvt_pk_bf16_f32 v204, v233, v234
    v_exp_f32 v236, v27
    v_mfma_f32_32x32x16_bf16 v[0:15], a[92:95], a[28:31], v[0:15]
    ds_read_b64_tr_b16 a[124:125], v219 offset:20480
    buffer_load_dwordx4 v223, s[24:27], s66 offen offset:1024 nt lds
    v_add_f32 v231, v231, v235
    v_exp_f32 v237, v28
    s_waitcnt lgkmcnt(7)
    v_mfma_f32_32x32x16_bf16 v[64:79], a[96:99], v[192:195], v[64:79]
    ds_read_b64_tr_b16 a[126:127], v219 offset:22528
    v_add_f32 v232, v232, v236
    v_cvt_pk_bf16_f32 v205, v235, v236
    v_exp_f32 v238, v29
    s_add_u32 m0, s50, 0
    v_mfma_f32_32x32x16_bf16 v[80:95], a[100:103], v[192:195], v[80:95]
    buffer_load_dwordx4 v220, s[20:23], s68 offen nt lds
    v_add_f32 v231, v231, v237
    v_exp_f32 v233, v30
    v_mfma_f32_32x32x16_bf16 v[96:111], a[104:107], v[192:195], v[96:111]
    buffer_load_dwordx4 v221, s[20:23], s68 offen offset:1024 nt lds
    v_add_f32 v232, v232, v238
    v_cvt_pk_bf16_f32 v206, v237, v238
    s_add_u32 m0, s51, 57344
    v_mfma_f32_32x32x16_bf16 v[112:127], a[108:111], v[192:195], v[112:127]
    buffer_load_dwordx4 v222, s[24:27], s67 offen nt lds
    v_exp_f32 v234, v31
    s_waitcnt lgkmcnt(0)
    v_mfma_f32_32x32x16_bf16 v[64:79], a[112:115], v[196:199], v[64:79]
    buffer_load_dwordx4 v223, s[24:27], s67 offen offset:1024 nt lds
    v_add_f32 v231, v231, v233
    v_add_f32 v232, v232, v234
    v_cvt_pk_bf16_f32 v207, v233, v234
    v_add_f32 v231, v231, v232
    v_cmp_lt_f32 vcc, s52, v231
    v_mfma_f32_32x32x16_bf16 v[80:95], a[116:119], v[196:199], v[80:95]
    v_exp_f32 v229, v0
    v_mfma_f32_32x32x16_bf16 v[96:111], a[120:123], v[196:199], v[96:111]
    s_cbranch_vccnz L_fb1_p2
L_fb1_ret_p2:
    v_add_f32 v226, v226, v231
    v_exp_f32 v230, v1
    s_add_u32 s44, s44, 1
    s_cmp_ge_u32 s44, s43
    v_mfma_f32_32x32x16_bf16 v[112:127], a[124:127], v[196:199], v[112:127]
    s_cbranch_scc1 L_drain
    s_branch L_body_3
L_body_0:
    s_waitcnt vmcnt(12)
    s_barrier
    v_mfma_f32_32x32x16_bf16 v[16:31], a[64:67], a[32:35], v[48:63]
    v_exp_f32 v233, v2
    v_cvt_pk_bf16_f32 v192, v229, v230
    v_exp_f32 v234, v3
    v_add_f32 v229, v229, v233
    v_mfma_f32_32x32x16_bf16 v[16:31], a[68:71], a[36:39], v[16:31]
    ds_read_b128 a[64:67], v208 offset:8192
    v_exp_f32 v235, v4
    v_add_f32 v230, v230, v234
    v_cvt_pk_bf16_f32 v193, v233, v234
    v_mfma_f32_32x32x16_bf16 v[16:31], a[72:75], a[40:43], v[16:31]
    ds_read_b128 a[68:71], v209 offset:8192
    v_exp_f32 v236, v5
    v_add_f32 v229, v229, v235
    v_mfma_f32_32x32x16_bf16 v[16:31], a[76:79], a[44:47], v[16:31]
    ds_read_b128 a[72:75], v210 offset:8192
    v_exp_f32 v237, v6
    v_add_f32 v230, v230, v236
    v_cvt_pk_bf16_f32 v194, v235, v236
    v_mfma_f32_32x32x16_bf16 v[16:31], a[80:83], a[48:51], v[16:31]
    ds_read_b128 a[76:79], v211 offset:8192
    v_exp_f32 v238, v7
    v_add_f32 v229, v229, v237
    v_exp_f32 v233, v8
    v_mfma_f32_32x32x16_bf16 v[16:31], a[84:87], a[52:55], v[16:31]
    ds_read_b128 a[80:83], v212 offset:8192
    v_add_f32 v230, v230, v238
    v_cvt_pk_bf16_f32 v195, v237, v238
    v_exp_f32 v234, v9
    v_mfma_f32_32x32x16_bf16 v[16:31], a[88:91], a[56:59], v[16:31]
    ds_read_b128 a[84:87], v213 offset:8192
    v_add_f32 v229, v229, v233
    v_exp_f32 v235, v10
    v_add_f32 v230, v230, v234
    v_mfma_f32_32x32x16_bf16 v[16:31], a[92:95], a[60:63], v[16:31]
    ds_read_b128 a[88:91], v214 offset:8192
    v_cvt_pk_bf16_f32 v196, v233, v234
    v_exp_f32 v236, v11
    v_add_f32 v229, v229, v235
    v_mfma_f32_32x32x16_bf16 v[128:143], a[96:99], v[200:203], v[128:143]
    ds_read_b128 a[92:95], v215 offset:8192
    v_exp_f32 v237, v12
    v_add_f32 v230, v230, v236
    v_cvt_pk_bf16_f32 v197, v235, v236
    s_cmp_eq_u32 s44, s45
    v_mfma_f32_32x32x16_bf16 v[144:159], a[100:103], v[200:203], v[144:159]
    s_cbranch_scc1 L_patch_0
L_patch_ret_0:
    ds_read_b64_tr_b16 a[96:97], v216 offset:0
    v_exp_f32 v238, v13
    v_mfma_f32_32x32x16_bf16 v[160:175], a[104:107], v[200:203], v[160:175]
    ds_read_b64_tr_b16 a[98:99], v216 offset:2048
    v_add_f32 v229, v229, v237
    v_exp_f32 v233, v14
    v_add_f32 v230, v230, v238
    v_mfma_f32_32x32x16_bf16 v[176:191], a[108:111], v[200:203], v[176:191]
    ds_read_b64_tr_b16 a[100:101], v217 offset:0
    v_cvt_pk_bf16_f32 v198, v237, v238
    v_exp_f32 v234, v15
    v_add_f32 v229, v229, v233
    v_mfma_f32_32x32x16_bf16 v[128:143], a[112:115], v[204:207], v[128:143]
    ds_read_b64_tr_b16 a[102:103], v217 offset:2048
    v_add_f32 v230, v230, v234
    v_cvt_pk_bf16_f32 v199, v233, v234
    v_add_f32 v229, v229, v230
    v_cmp_lt_f32 vcc, s52, v229
    v_mfma_f32_32x32x16_bf16 v[144:159], a[116:119], v[204:207], v[144:159]
    ds_read_b64_tr_b16 a[104:105], v218 offset:0
    v_exp_f32 v231, v16
    v_exp_f32 v232, v17
    v_mfma_f32_32x32x16_bf16 v[160:175], a[120:123], v[204:207], v[160:175]
    s_cbranch_vccnz L_fb0_0
L_fb0_ret_0:
    ds_read_b64_tr_b16 a[106:107], v218 offset:2048
    v_add_f32 v225, v225, v229
    v_exp_f32 v233, v18
    v_mfma_f32_32x32x16_bf16 v[176:191], a[124:127], v[204:207], v[176:191]
    ds_read_b64_tr_b16 a[108:109], v219 offset:0
    v_cvt_pk_bf16_f32 v200, v231, v232
    v_exp_f32 v234, v19
    s_waitcnt lgkmcnt(7)
    v_mfma_f32_32x32x16_bf16 v[0:15], a[64:67], a[0:3], v[32:47]
    ds_read_b64_tr_b16 a[110:111], v219 offset:2048
    v_add_f32 v231, v231, v233
    v_exp_f32 v235, v20
    v_add_f32 v232, v232, v234
    v_mfma_f32_32x32x16_bf16 v[0:15], a[68:71], a[4:7], v[0:15]
    ds_read_b64_tr_b16 a[112:113], v216 offset:4096
    v_cvt_pk_bf16_f32 v201, v233, v234
    v_exp_f32 v236, v21
    v_add_f32 v231, v231, v235
    v_mfma_f32_32x32x16_bf16 v[0:15], a[72:75], a[8:11], v[0:15]
    ds_read_b64_tr_b16 a[114:115], v216 offset:6144
    v_exp_f32 v237, v22
    v_add_f32 v232, v232, v236
    v_cvt_pk_bf16_f32 v202, v235, v236
    v_mfma_f32_32x32x16_bf16 v[0:15], a[76:79], a[12:15], v[0:15]
    ds_read_b64_tr_b16 a[116:117], v217 offset:4096
    v_exp_f32 v238, v23
    v_add_f32 v231, v231, v237
    v_exp_f32 v233, v24
    v_mfma_f32_32x32x16_bf16 v[0:15], a[80:83], a[16:19], v[0:15]
    ds_read_b64_tr_b16 a[118:119], v217 offset:6144
    v_add_f32 v232, v232, v238
    v_cvt_pk_bf16_f32 v203, v237, v238
    v_exp_f32 v234, v25
    v_mfma_f32_32x32x16_bf16 v[0:15], a[84:87], a[20:23], v[0:15]
    ds_read_b64_tr_b16 a[120:121], v218 offset:4096
    v_add_f32 v231, v231, v233
    v_exp_f32 v235, v26
    v_mfma_f32_32x32x16_bf16 v[0:15], a[88:91], a[24:27], v[0:15]
    ds_read_b64_tr_b16 a[122:123], v218 offset:6144
    v_readlane_b32 s48, v224, s47
    v_add_f32 v232, v232, v234
    v_cvt_pk_bf16_f32 v204, v233, v234
    v_exp_f32 v236, v27
    s_add_u32 s47, s47, 1
    v_mfma_f32_32x32x16_bf16 v[0:15], a[92:95], a[28:31], v[0:15]
    ds_read_b64_tr_b16 a[124:125], v219 offset:4096
    v_add_f32 v231, v231, v235
    v_exp_f32 v237, v28
    s_waitcnt lgkmcnt(7)
    v_mfma_f32_32x32x16_bf16 v[64:79], a[96:99], v[192:195], v[64:79]
    ds_read_b64_tr_b16 a[126:127], v219 offset:6144
    v_add_f32 v232, v232, v236
    v_cvt_pk_bf16_f32 v205, v235, v236
    v_exp_f32 v238, v29
    s_add_u32 m0, s51, 40960
    v_mfma_f32_32x32x16_bf16 v[80:95], a[100:103], v[192:195], v[80:95]
    buffer_load_dwordx4 v222, s[24:27], s49 offen nt lds
    v_add_f32 v231, v231, v237
    v_exp_f32 v233, v30
    v_mfma_f32_32x32x16_bf16 v[96:111], a[104:107], v[192:195], v[96:111]
    buffer_load_dwordx4 v223, s[24:27], s49 offen offset:1024 nt lds
    v_add_f32 v232, v232, v238
    v_cvt_pk_bf16_f32 v206, v237, v238
    s_add_u32 m0, s50, 49152
    v_mfma_f32_32x32x16_bf16 v[112:127], a[108:111], v[192:195], v[112:127]
    buffer_load_dwordx4 v220, s[20:23], s48 offen nt lds
    v_exp_f32 v234, v31
    s_waitcnt lgkmcnt(0)
    v_mfma_f32_32x32x16_bf16 v[64:79], a[112:115], v[196:199], v[64:79]
    v_add_f32 v231, v231, v233
    v_add_f32 v232, v232, v234
    v_cvt_pk_bf16_f32 v207, v233, v234
    v_add_f32 v231, v231, v232
    v_cmp_lt_f32 vcc, s52, v231
    v_mfma_f32_32x32x16_bf16 v[80:95], a[116:119], v[196:199], v[80:95]
    buffer_load_dwordx4 v221, s[20:23], s48 offen offset:1024 nt lds
    v_exp_f32 v229, v0
    v_mfma_f32_32x32x16_bf16 v[96:111], a[120:123], v[196:199], v[96:111]
    s_cbranch_vccnz L_fb1_0
L_fb1_ret_0:
    v_add_f32 v226, v226, v231
    v_exp_f32 v230, v1
    s_add_u32 s44, s44, 1
    s_cmp_ge_u32 s44, s43
    v_mfma_f32_32x32x16_bf16 v[112:127], a[124:127], v[196:199], v[112:127]
    s_cbranch_scc1 L_drain
L_body_1:
    v_mfma_f32_32x32x16_bf16 v[16:31], a[64:67], a[32:35], v[48:63]
    v_exp_f32 v233, v2
    v_cvt_pk_bf16_f32 v192, v229, v230
    v_exp_f32 v234, v3
    v_add_f32 v229, v229, v233
    v_mfma_f32_32x32x16_bf16 v[16:31], a[68:71], a[36:39], v[16:31]
    ds_read_b128 a[64:67], v208 offset:16384
    v_exp_f32 v235, v4
    v_add_f32 v230, v230, v234
    v_cvt_pk_bf16_f32 v193, v233, v234
    v_mfma_f32_32x32x16_bf16 v[16:31], a[72:75], a[40:43], v[16:31]
    ds_read_b128 a[68:71], v209 offset:16384
    v_exp_f32 v236, v5
    v_add_f32 v229, v229, v235
    v_mfma_f32_32x32x16_bf16 v[16:31], a[76:79], a[44:47], v[16:31]
    ds_read_b128 a[72:75], v210 offset:16384
    v_exp_f32 v237, v6
    v_add_f32 v230, v230, v236
    v_cvt_pk_bf16_f32 v194, v235, v236
    v_mfma_f32_32x32x16_bf16 v[16:31], a[80:83], a[48:51], v[16:31]
    ds_read_b128 a[76:79], v211 offset:16384
    v_exp_f32 v238, v7
    v_add_f32 v229, v229, v237
    v_exp_f32 v233, v8
    v_mfma_f32_32x32x16_bf16 v[16:31], a[84:87], a[52:55], v[16:31]
    ds_read_b128 a[80:83], v212 offset:16384
    v_add_f32 v230, v230, v238
    v_cvt_pk_bf16_f32 v195, v237, v238
    v_exp_f32 v234, v9
    v_mfma_f32_32x32x16_bf16 v[16:31], a[88:91], a[56:59], v[16:31]
    ds_read_b128 a[84:87], v213 offset:16384
    v_add_f32 v229, v229, v233
    v_exp_f32 v235, v10
    v_add_f32 v230, v230, v234
    v_mfma_f32_32x32x16_bf16 v[16:31], a[92:95], a[60:63], v[16:31]
    ds_read_b128 a[88:91], v214 offset:16384
    v_cvt_pk_bf16_f32 v196, v233, v234
    v_exp_f32 v236, v11
    v_add_f32 v229, v229, v235
    v_mfma_f32_32x32x16_bf16 v[128:143], a[96:99], v[200:203], v[128:143]
    ds_read_b128 a[92:95], v215 offset:16384
    v_exp_f32 v237, v12
    v_add_f32 v230, v230, v236
    v_cvt_pk_bf16_f32 v197, v235, v236
    s_cmp_eq_u32 s44, s45
    v_mfma_f32_32x32x16_bf16 v[144:159], a[100:103], v[200:203], v[144:159]
    s_cbranch_scc1 L_patch_1
L_patch_ret_1:
    ds_read_b64_tr_b16 a[96:97], v216 offset:8192
    v_exp_f32 v238, v13
    v_mfma_f32_32x32x16_bf16 v[160:175], a[104:107], v[200:203], v[160:175]
    ds_read_b64_tr_b16 a[98:99], v216 offset:10240
    v_add_f32 v229, v229, v237
    v_exp_f32 v233, v14
    v_add_f32 v230, v230, v238
    v_mfma_f32_32x32x16_bf16 v[176:191], a[108:111], v[200:203], v[176:191]
    ds_read_b64_tr_b16 a[100:101], v217 offset:8192
    v_cvt_pk_bf16_f32 v198, v237, v238
    v_exp_f32 v234, v15
    v_add_f32 v229, v229, v233
    v_mfma_f32_32x32x16_bf16 v[128:143], a[112:115], v[204:207], v[128:143]
    ds_read_b64_tr_b16 a[102:103], v217 offset:10240
    v_add_f32 v230, v230, v234
    v_cvt_pk_bf16_f32 v199, v233, v234
    v_add_f32 v229, v229, v230
    v_cmp_lt_f32 vcc, s52, v229
    v_mfma_f32_32x32x16_bf16 v[144:159], a[116:119], v[204:207], v[144:159]
    ds_read_b64_tr_b16 a[104:105], v218 offset:8192
    v_exp_f32 v231, v16
    v_exp_f32 v232, v17
    v_mfma_f32_32x32x16_bf16 v[160:175], a[120:123], v[204:207], v[160:175]
    s_cbranch_vccnz L_fb0_1
L_fb0_ret_1:
    ds_read_b64_tr_b16 a[106:107], v218 offset:10240
    v_add_f32 v225, v225, v229
    v_exp_f32 v233, v18
    v_mfma_f32_32x32x16_bf16 v[176:191], a[124:127], v[204:207], v[176:191]
    ds_read_b64_tr_b16 a[108:109], v219 offset:8192
    v_cvt_pk_bf16_f32 v200, v231, v232
    v_exp_f32 v234, v19
    s_waitcnt lgkmcnt(7)
    v_mfma_f32_32x32x16_bf16 v[0:15], a[64:67], a[0:3], v[32:47]
    ds_read_b64_tr_b16 a[110:111], v219 offset:10240
    v_add_f32 v231, v231, v233
    v_exp_f32 v235, v20
    v_add_f32 v232, v232, v234
    v_mfma_f32_32x32x16_bf16 v[0:15], a[68:71], a[4:7], v[0:15]
    ds_read_b64_tr_b16 a[112:113], v216 offset:12288
    v_cvt_pk_bf16_f32 v201, v233, v234
    v_exp_f32 v236, v21
    v_add_f32 v231, v231, v235
    v_mfma_f32_32x32x16_bf16 v[0:15], a[72:75], a[8:11], v[0:15]
    ds_read_b64_tr_b16 a[114:115], v216 offset:14336
    v_exp_f32 v237, v22
    v_add_f32 v232, v232, v236
    v_cvt_pk_bf16_f32 v202, v235, v236
    v_mfma_f32_32x32x16_bf16 v[0:15], a[76:79], a[12:15], v[0:15]
    ds_read_b64_tr_b16 a[116:117], v217 offset:12288
    v_exp_f32 v238, v23
    v_add_f32 v231, v231, v237
    v_exp_f32 v233, v24
    v_mfma_f32_32x32x16_bf16 v[0:15], a[80:83], a[16:19], v[0:15]
    ds_read_b64_tr_b16 a[118:119], v217 offset:14336
    v_add_f32 v232, v232, v238
    v_cvt_pk_bf16_f32 v203, v237, v238
    v_exp_f32 v234, v25
    v_mfma_f32_32x32x16_bf16 v[0:15], a[84:87], a[20:23], v[0:15]
    ds_read_b64_tr_b16 a[120:121], v218 offset:12288
    v_add_f32 v231, v231, v233
    v_exp_f32 v235, v26
    v_mfma_f32_32x32x16_bf16 v[0:15], a[88:91], a[24:27], v[0:15]
    ds_read_b64_tr_b16 a[122:123], v218 offset:14336
    v_readlane_b32 s49, v224, s47
    v_add_f32 v232, v232, v234
    v_cvt_pk_bf16_f32 v204, v233, v234
    v_exp_f32 v236, v27
    s_add_u32 s47, s47, 1
    v_mfma_f32_32x32x16_bf16 v[0:15], a[92:95], a[28:31], v[0:15]
    ds_read_b64_tr_b16 a[124:125], v219 offset:12288
    v_add_f32 v231, v231, v235
    v_exp_f32 v237, v28
    s_waitcnt lgkmcnt(7)
    v_mfma_f32_32x32x16_bf16 v[64:79], a[96:99], v[192:195], v[64:79]
    ds_read_b64_tr_b16 a[126:127], v219 offset:14336
    v_add_f32 v232, v232, v236
    v_cvt_pk_bf16_f32 v205, v235, v236
    v_exp_f32 v238, v29
    s_add_u32 m0, s51, 49152
    v_mfma_f32_32x32x16_bf16 v[80:95], a[100:103], v[192:195], v[80:95]
    buffer_load_dwordx4 v222, s[24:27], s48 offen nt lds
    v_add_f32 v231, v231, v237
    v_exp_f32 v233, v30
    v_mfma_f32_32x32x16_bf16 v[96:111], a[104:107], v[192:195], v[96:111]
    buffer_load_dwordx4 v223, s[24:27], s48 offen offset:1024 nt lds
    v_add_f32 v232, v232, v238
    v_cvt_pk_bf16_f32 v206, v237, v238
    s_add_u32 m0, s50, 57344
    v_mfma_f32_32x32x16_bf16 v[112:127], a[108:111], v[192:195], v[112:127]
    buffer_load_dwordx4 v220, s[20:23], s49 offen nt lds
    v_exp_f32 v234, v31
    s_waitcnt lgkmcnt(0)
    v_mfma_f32_32x32x16_bf16 v[64:79], a[112:115], v[196:199], v[64:79]
    v_add_f32 v231, v231, v233
    v_add_f32 v232, v232, v234
    v_cvt_pk_bf16_f32 v207, v233, v234
    v_add_f32 v231, v231, v232
    v_cmp_lt_f32 vcc, s52, v231
    v_mfma_f32_32x32x16_bf16 v[80:95], a[116:119], v[196:199], v[80:95]
    buffer_load_dwordx4 v221, s[20:23], s49 offen offset:1024 nt lds
    v_exp_f32 v229, v0
    v_mfma_f32_32x32x16_bf16 v[96:111], a[120:123], v[196:199], v[96:111]
    s_cbranch_vccnz L_fb1_1
L_fb1_ret_1:
    v_add_f32 v226, v226, v231
    v_exp_f32 v230, v1
    s_add_u32 s44, s44, 1
    s_cmp_ge_u32 s44, s43
    v_mfma_f32_32x32x16_bf16 v[112:127], a[124:127], v[196:199], v[112:127]
    s_cbranch_scc1 L_drain
L_body_2:
    s_waitcnt vmcnt(12)
    s_barrier
    v_mfma_f32_32x32x16_bf16 v[16:31], a[64:67], a[32:35], v[48:63]
    v_exp_f32 v233, v2
    v_cvt_pk_bf16_f32 v192, v229, v230
    v_exp_f32 v234, v3
    v_add_f32 v229, v229, v233
    v_mfma_f32_32x32x16_bf16 v[16:31], a[68:71], a[36:39], v[16:31]
    ds_read_b128 a[64:67], v208 offset:24576
    v_exp_f32 v235, v4
    v_add_f32 v230, v230, v234
    v_cvt_pk_bf16_f32 v193, v233, v234
    v_mfma_f32_32x32x16_bf16 v[16:31], a[72:75], a[40:43], v[16:31]
    ds_read_b128 a[68:71], v209 offset:24576
    v_exp_f32 v236, v5
    v_add_f32 v229, v229, v235
    v_mfma_f32_32x32x16_bf16 v[16:31], a[76:79], a[44:47], v[16:31]
    ds_read_b128 a[72:75], v210 offset:24576
    v_exp_f32 v237, v6
    v_add_f32 v230, v230, v236
    v_cvt_pk_bf16_f32 v194, v235, v236
    v_mfma_f32_32x32x16_bf16 v[16:31], a[80:83], a[48:51], v[16:31]
    ds_read_b128 a[76:79], v211 offset:24576
    v_exp_f32 v238, v7
    v_add_f32 v229, v229, v237
    v_exp_f32 v233, v8
    v_mfma_f32_32x32x16_bf16 v[16:31], a[84:87], a[52:55], v[16:31]
    ds_read_b128 a[80:83], v212 offset:24576
    v_add_f32 v230, v230, v238
    v_cvt_pk_bf16_f32 v195, v237, v238
    v_exp_f32 v234, v9
    v_mfma_f32_32x32x16_bf16 v[16:31], a[88:91], a[56:59], v[16:31]
    ds_read_b128 a[84:87], v213 offset:24576
    v_add_f32 v229, v229, v233
    v_exp_f32 v235, v10
    v_add_f32 v230, v230, v234
    v_mfma_f32_32x32x16_bf16 v[16:31], a[92:95], a[60:63], v[16:31]
    ds_read_b128 a[88:91], v214 offset:24576
    v_cvt_pk_bf16_f32 v196, v233, v234
    v_exp_f32 v236, v11
    v_add_f32 v229, v229, v235
    v_mfma_f32_32x32x16_bf16 v[128:143], a[96:99], v[200:203], v[128:143]
    ds_read_b128 a[92:95], v215 offset:24576
    v_exp_f32 v237, v12
    v_add_f32 v230, v230, v236
    v_cvt_pk_bf16_f32 v197, v235, v236
    s_cmp_eq_u32 s44, s45
    v_mfma_f32_32x32x16_bf16 v[144:159], a[100:103], v[200:203], v[144:159]
    s_cbranch_scc1 L_patch_2
L_patch_ret_2:
    ds_read_b64_tr_b16 a[96:97], v216 offset:16384
    v_exp_f32 v238, v13
    v_mfma_f32_32x32x16_bf16 v[160:175], a[104:107], v[200:203], v[160:175]
    ds_read_b64_tr_b16 a[98:99], v216 offset:18432
    v_add_f32 v229, v229, v237
    v_exp_f32 v233, v14
    v_add_f32 v230, v230, v238
    v_mfma_f32_32x32x16_bf16 v[176:191], a[108:111], v[200:203], v[176:191]
    ds_read_b64_tr_b16 a[100:101], v217 offset:16384
    v_cvt_pk_bf16_f32 v198, v237, v238
    v_exp_f32 v234, v15
    v_add_f32 v229, v229, v233
    v_mfma_f32_32x32x16_bf16 v[128:143], a[112:115], v[204:207], v[128:143]
    ds_read_b64_tr_b16 a[102:103], v217 offset:18432
    v_add_f32 v230, v230, v234
    v_cvt_pk_bf16_f32 v199, v233, v234
    v_add_f32 v229, v229, v230
    v_cmp_lt_f32 vcc, s52, v229
    v_mfma_f32_32x32x16_bf16 v[144:159], a[116:119], v[204:207], v[144:159]
    ds_read_b64_tr_b16 a[104:105], v218 offset:16384
    v_exp_f32 v231, v16
    v_exp_f32 v232, v17
    v_mfma_f32_32x32x16_bf16 v[160:175], a[120:123], v[204:207], v[160:175]
    s_cbranch_vccnz L_fb0_2
L_fb0_ret_2:
    ds_read_b64_tr_b16 a[106:107], v218 offset:18432
    v_add_f32 v225, v225, v229
    v_exp_f32 v233, v18
    v_mfma_f32_32x32x16_bf16 v[176:191], a[124:127], v[204:207], v[176:191]
    ds_read_b64_tr_b16 a[108:109], v219 offset:16384
    v_cvt_pk_bf16_f32 v200, v231, v232
    v_exp_f32 v234, v19
    s_waitcnt lgkmcnt(7)
    v_mfma_f32_32x32x16_bf16 v[0:15], a[64:67], a[0:3], v[32:47]
    ds_read_b64_tr_b16 a[110:111], v219 offset:18432
    v_add_f32 v231, v231, v233
    v_exp_f32 v235, v20
    v_add_f32 v232, v232, v234
    v_mfma_f32_32x32x16_bf16 v[0:15], a[68:71], a[4:7], v[0:15]
    ds_read_b64_tr_b16 a[112:113], v216 offset:20480
    v_cvt_pk_bf16_f32 v201, v233, v234
    v_exp_f32 v236, v21
    v_add_f32 v231, v231, v235
    v_mfma_f32_32x32x16_bf16 v[0:15], a[72:75], a[8:11], v[0:15]
    ds_read_b64_tr_b16 a[114:115], v216 offset:22528
    v_exp_f32 v237, v22
    v_add_f32 v232, v232, v236
    v_cvt_pk_bf16_f32 v202, v235, v236
    v_mfma_f32_32x32x16_bf16 v[0:15], a[76:79], a[12:15], v[0:15]
    ds_read_b64_tr_b16 a[116:117], v217 offset:20480
    v_exp_f32 v238, v23
    v_add_f32 v231, v231, v237
    v_exp_f32 v233, v24
    v_mfma_f32_32x32x16_bf16 v[0:15], a[80:83], a[16:19], v[0:15]
    ds_read_b64_tr_b16 a[118:119], v217 offset:22528
    v_add_f32 v232, v232, v238
    v_cvt_pk_bf16_f32 v203, v237, v238
    v_exp_f32 v234, v25
    v_mfma_f32_32x32x16_bf16 v[0:15], a[84:87], a[20:23], v[0:15]
    ds_read_b64_tr_b16 a[120:121], v218 offset:20480
    v_add_f32 v231, v231, v233
    v_exp_f32 v235, v26
    v_mfma_f32_32x32x16_bf16 v[0:15], a[88:91], a[24:27], v[0:15]
    ds_read_b64_tr_b16 a[122:123], v218 offset:22528
    v_readlane_b32 s48, v224, s47
    v_add_f32 v232, v232, v234
    v_cvt_pk_bf16_f32 v204, v233, v234
    v_exp_f32 v236, v27
    s_add_u32 s47, s47, 1
    v_mfma_f32_32x32x16_bf16 v[0:15], a[92:95], a[28:31], v[0:15]
    ds_read_b64_tr_b16 a[124:125], v219 offset:20480
    v_add_f32 v231, v231, v235
    v_exp_f32 v237, v28
    s_waitcnt lgkmcnt(7)
    v_mfma_f32_32x32x16_bf16 v[64:79], a[96:99], v[192:195], v[64:79]
    ds_read_b64_tr_b16 a[126:127], v219 offset:22528
    v_add_f32 v232, v232, v236
    v_cvt_pk_bf16_f32 v205, v235, v236
    v_exp_f32 v238, v29
    s_add_u32 m0, s51, 57344
    v_mfma_f32_32x32x16_bf16 v[80:95], a[100:103], v[192:195], v[80:95]
    buffer_load_dwordx4 v222, s[24:27], s49 offen nt lds
    v_add_f32 v231, v231, v237
    v_exp_f32 v233, v30
    v_mfma_f32_32x32x16_bf16 v[96:111], a[104:107], v[192:195], v[96:111]
    buffer_load_dwordx4 v223, s[24:27], s49 offen offset:1024 nt lds
    v_add_f32 v232, v232, v238
    v_cvt_pk_bf16_f32 v206, v237, v238
    s_add_u32 m0, s50, 0
    v_mfma_f32_32x32x16_bf16 v[112:127], a[108:111], v[192:195], v[112:127]
    buffer_load_dwordx4 v220, s[20:23], s48 offen nt lds
    v_exp_f32 v234, v31
    s_waitcnt lgkmcnt(0)
    v_mfma_f32_32x32x16_bf16 v[64:79], a[112:115], v[196:199], v[64:79]
    v_add_f32 v231, v231, v233
    v_add_f32 v232, v232, v234
    v_cvt_pk_bf16_f32 v207, v233, v234
    v_add_f32 v231, v231, v232
    v_cmp_lt_f32 vcc, s52, v231
    v_mfma_f32_32x32x16_bf16 v[80:95], a[116:119], v[196:199], v[80:95]
    buffer_load_dwordx4 v221, s[20:23], s48 offen offset:1024 nt lds
    v_exp_f32 v229, v0
    v_mfma_f32_32x32x16_bf16 v[96:111], a[120:123], v[196:199], v[96:111]
    s_cbranch_vccnz L_fb1_2
L_fb1_ret_2:
    v_add_f32 v226, v226, v231
    v_exp_f32 v230, v1
    s_add_u32 s44, s44, 1
    s_cmp_ge_u32 s44, s43
    v_mfma_f32_32x32x16_bf16 v[112:127], a[124:127], v[196:199], v[112:127]
    s_cbranch_scc1 L_drain
L_body_3:
    v_mfma_f32_32x32x16_bf16 v[16:31], a[64:67], a[32:35], v[48:63]
    v_exp_f32 v233, v2
    v_cvt_pk_bf16_f32 v192, v229, v230
    v_exp_f32 v234, v3
    v_add_f32 v229, v229, v233
    v_mfma_f32_32x32x16_bf16 v[16:31], a[68:71], a[36:39], v[16:31]
    ds_read_b128 a[64:67], v208 offset:32768
    v_exp_f32 v235, v4
    v_add_f32 v230, v230, v234
    v_cvt_pk_bf16_f32 v193, v233, v234
    v_mfma_f32_32x32x16_bf16 v[16:31], a[72:75], a[40:43], v[16:31]
    ds_read_b128 a[68:71], v209 offset:32768
    v_exp_f32 v236, v5
    v_add_f32 v229, v229, v235
    v_mfma_f32_32x32x16_bf16 v[16:31], a[76:79], a[44:47], v[16:31]
    ds_read_b128 a[72:75], v210 offset:32768
    v_exp_f32 v237, v6
    v_add_f32 v230, v230, v236
    v_cvt_pk_bf16_f32 v194, v235, v236
    v_mfma_f32_32x32x16_bf16 v[16:31], a[80:83], a[48:51], v[16:31]
    ds_read_b128 a[76:79], v211 offset:32768
    v_exp_f32 v238, v7
    v_add_f32 v229, v229, v237
    v_exp_f32 v233, v8
    v_mfma_f32_32x32x16_bf16 v[16:31], a[84:87], a[52:55], v[16:31]
    ds_read_b128 a[80:83], v212 offset:32768
    v_add_f32 v230, v230, v238
    v_cvt_pk_bf16_f32 v195, v237, v238
    v_exp_f32 v234, v9
    v_mfma_f32_32x32x16_bf16 v[16:31], a[88:91], a[56:59], v[16:31]
    ds_read_b128 a[84:87], v213 offset:32768
    v_add_f32 v229, v229, v233
    v_exp_f32 v235, v10
    v_add_f32 v230, v230, v234
    v_mfma_f32_32x32x16_bf16 v[16:31], a[92:95], a[60:63], v[16:31]
    ds_read_b128 a[88:91], v214 offset:32768
    v_cvt_pk_bf16_f32 v196, v233, v234
    v_exp_f32 v236, v11
    v_add_f32 v229, v229, v235
    v_mfma_f32_32x32x16_bf16 v[128:143], a[96:99], v[200:203], v[128:143]
    ds_read_b128 a[92:95], v215 offset:32768
    v_exp_f32 v237, v12
    v_add_f32 v230, v230, v236
    v_cvt_pk_bf16_f32 v197, v235, v236
    s_cmp_eq_u32 s44, s45
    v_mfma_f32_32x32x16_bf16 v[144:159], a[100:103], v[200:203], v[144:159]
    s_cbranch_scc1 L_patch_3
L_patch_ret_3:
    ds_read_b64_tr_b16 a[96:97], v216 offset:24576
    v_exp_f32 v238, v13
    v_mfma_f32_32x32x16_bf16 v[160:175], a[104:107], v[200:203], v[160:175]
    ds_read_b64_tr_b16 a[98:99], v216 offset:26624
    v_add_f32 v229, v229, v237
    v_exp_f32 v233, v14
    v_add_f32 v230, v230, v238
    v_mfma_f32_32x32x16_bf16 v[176:191], a[108:111], v[200:203], v[176:191]
    ds_read_b64_tr_b16 a[100:101], v217 offset:24576
    v_cvt_pk_bf16_f32 v198, v237, v238
    v_exp_f32 v234, v15
    v_add_f32 v229, v229, v233
    v_mfma_f32_32x32x16_bf16 v[128:143], a[112:115], v[204:207], v[128:143]
    ds_read_b64_tr_b16 a[102:103], v217 offset:26624
    v_add_f32 v230, v230, v234
    v_cvt_pk_bf16_f32 v199, v233, v234
    v_add_f32 v229, v229, v230
    v_cmp_lt_f32 vcc, s52, v229
    v_mfma_f32_32x32x16_bf16 v[144:159], a[116:119], v[204:207], v[144:159]
    ds_read_b64_tr_b16 a[104:105], v218 offset:24576
    v_exp_f32 v231, v16
    v_exp_f32 v232, v17
    v_mfma_f32_32x32x16_bf16 v[160:175], a[120:123], v[204:207], v[160:175]
    s_cbranch_vccnz L_fb0_3
L_fb0_ret_3:
    ds_read_b64_tr_b16 a[106:107], v218 offset:26624
    v_add_f32 v225, v225, v229
    v_exp_f32 v233, v18
    v_mfma_f32_32x32x16_bf16 v[176:191], a[124:127], v[204:207], v[176:191]
    ds_read_b64_tr_b16 a[108:109], v219 offset:24576
    v_cvt_pk_bf16_f32 v200, v231, v232
    v_exp_f32 v234, v19
    s_waitcnt lgkmcnt(7)
    v_mfma_f32_32x32x16_bf16 v[0:15], a[64:67], a[0:3], v[32:47]
    ds_read_b64_tr_b16 a[110:111], v219 offset:26624
    v_add_f32 v231, v231, v233
    v_exp_f32 v235, v20
    v_add_f32 v232, v232, v234
    v_mfma_f32_32x32x16_bf16 v[0:15], a[68:71], a[4:7], v[0:15]
    ds_read_b64_tr_b16 a[112:113], v216 offset:28672
    v_cvt_pk_bf16_f32 v201, v233, v234
    v_exp_f32 v236, v21
    v_add_f32 v231, v231, v235
    v_mfma_f32_32x32x16_bf16 v[0:15], a[72:75], a[8:11], v[0:15]
    ds_read_b64_tr_b16 a[114:115], v216 offset:30720
    v_exp_f32 v237, v22
    v_add_f32 v232, v232, v236
    v_cvt_pk_bf16_f32 v202, v235, v236
    v_mfma_f32_32x32x16_bf16 v[0:15], a[76:79], a[12:15], v[0:15]
    ds_read_b64_tr_b16 a[116:117], v217 offset:28672
    v_exp_f32 v238, v23
    v_add_f32 v231, v231, v237
    v_exp_f32 v233, v24
    v_mfma_f32_32x32x16_bf16 v[0:15], a[80:83], a[16:19], v[0:15]
    ds_read_b64_tr_b16 a[118:119], v217 offset:30720
    v_add_f32 v232, v232, v238
    v_cvt_pk_bf16_f32 v203, v237, v238
    v_exp_f32 v234, v25
    v_mfma_f32_32x32x16_bf16 v[0:15], a[84:87], a[20:23], v[0:15]
    ds_read_b64_tr_b16 a[120:121], v218 offset:28672
    v_add_f32 v231, v231, v233
    v_exp_f32 v235, v26
    v_mfma_f32_32x32x16_bf16 v[0:15], a[88:91], a[24:27], v[0:15]
    ds_read_b64_tr_b16 a[122:123], v218 offset:30720
    v_readlane_b32 s49, v224, s47
    v_add_f32 v232, v232, v234
    v_cvt_pk_bf16_f32 v204, v233, v234
    v_exp_f32 v236, v27
    s_add_u32 s47, s47, 1
    v_mfma_f32_32x32x16_bf16 v[0:15], a[92:95], a[28:31], v[0:15]
    ds_read_b64_tr_b16 a[124:125], v219 offset:28672
    v_add_f32 v231, v231, v235
    v_exp_f32 v237, v28
    s_waitcnt lgkmcnt(7)
    v_mfma_f32_32x32x16_bf16 v[64:79], a[96:99], v[192:195], v[64:79]
    ds_read_b64_tr_b16 a[126:127], v219 offset:30720
    v_add_f32 v232, v232, v236
    v_cvt_pk_bf16_f32 v205, v235, v236
    v_exp_f32 v238, v29
    s_add_u32 m0, s51, 0
    v_mfma_f32_32x32x16_bf16 v[80:95], a[100:103], v[192:195], v[80:95]
    buffer_load_dwordx4 v222, s[24:27], s48 offen nt lds
    v_add_f32 v231, v231, v237
    v_exp_f32 v233, v30
    v_mfma_f32_32x32x16_bf16 v[96:111], a[104:107], v[192:195], v[96:111]
    buffer_load_dwordx4 v223, s[24:27], s48 offen offset:1024 nt lds
    v_add_f32 v232, v232, v238
    v_cvt_pk_bf16_f32 v206, v237, v238
    s_add_u32 m0, s50, 8192
    v_mfma_f32_32x32x16_bf16 v[112:127], a[108:111], v[192:195], v[112:127]
    buffer_load_dwordx4 v220, s[20:23], s49 offen nt lds
    v_exp_f32 v234, v31
    s_waitcnt lgkmcnt(0)
    v_mfma_f32_32x32x16_bf16 v[64:79], a[112:115], v[196:199], v[64:79]
    v_add_f32 v231, v231, v233
    v_add_f32 v232, v232, v234
    v_cvt_pk_bf16_f32 v207, v233, v234
    v_add_f32 v231, v231, v232
    v_cmp_lt_f32 vcc, s52, v231
    v_mfma_f32_32x32x16_bf16 v[80:95], a[116:119], v[196:199], v[80:95]
    buffer_load_dwordx4 v221, s[20:23], s49 offen offset:1024 nt lds
    v_exp_f32 v229, v0
    v_mfma_f32_32x32x16_bf16 v[96:111], a[120:123], v[196:199], v[96:111]
    s_cbranch_vccnz L_fb1_3
L_fb1_ret_3:
    v_add_f32 v226, v226, v231
    v_exp_f32 v230, v1
    s_add_u32 s44, s44, 1
    s_cmp_ge_u32 s44, s43
    v_mfma_f32_32x32x16_bf16 v[112:127], a[124:127], v[196:199], v[112:127]
    s_cbranch_scc1 L_drain
L_body_4:
    s_waitcnt vmcnt(12)
    s_barrier
    v_mfma_f32_32x32x16_bf16 v[16:31], a[64:67], a[32:35], v[48:63]
    v_exp_f32 v233, v2
    v_cvt_pk_bf16_f32 v192, v229, v230
    v_exp_f32 v234, v3
    v_add_f32 v229, v229, v233
    v_mfma_f32_32x32x16_bf16 v[16:31], a[68:71], a[36:39], v[16:31]
    ds_read_b128 a[64:67], v208 offset:40960
    v_exp_f32 v235, v4
    v_add_f32 v230, v230, v234
    v_cvt_pk_bf16_f32 v193, v233, v234
    v_mfma_f32_32x32x16_bf16 v[16:31], a[72:75], a[40:43], v[16:31]
    ds_read_b128 a[68:71], v209 offset:40960
    v_exp_f32 v236, v5
    v_add_f32 v229, v229, v235
    v_mfma_f32_32x32x16_bf16 v[16:31], a[76:79], a[44:47], v[16:31]
    ds_read_b128 a[72:75], v210 offset:40960
    v_exp_f32 v237, v6
    v_add_f32 v230, v230, v236
    v_cvt_pk_bf16_f32 v194, v235, v236
    v_mfma_f32_32x32x16_bf16 v[16:31], a[80:83], a[48:51], v[16:31]
    ds_read_b128 a[76:79], v211 offset:40960
    v_exp_f32 v238, v7
    v_add_f32 v229, v229, v237
    v_exp_f32 v233, v8
    v_mfma_f32_32x32x16_bf16 v[16:31], a[84:87], a[52:55], v[16:31]
    ds_read_b128 a[80:83], v212 offset:40960
    v_add_f32 v230, v230, v238
    v_cvt_pk_bf16_f32 v195, v237, v238
    v_exp_f32 v234, v9
    v_mfma_f32_32x32x16_bf16 v[16:31], a[88:91], a[56:59], v[16:31]
    ds_read_b128 a[84:87], v213 offset:40960
    v_add_f32 v229, v229, v233
    v_exp_f32 v235, v10
    v_add_f32 v230, v230, v234
    v_mfma_f32_32x32x16_bf16 v[16:31], a[92:95], a[60:63], v[16:31]
    ds_read_b128 a[88:91], v214 offset:40960
    v_cvt_pk_bf16_f32 v196, v233, v234
    v_exp_f32 v236, v11
    v_add_f32 v229, v229, v235
    v_mfma_f32_32x32x16_bf16 v[128:143], a[96:99], v[200:203], v[128:143]
    ds_read_b128 a[92:95], v215 offset:40960
    v_exp_f32 v237, v12
    v_add_f32 v230, v230, v236
    v_cvt_pk_bf16_f32 v197, v235, v236
    s_cmp_eq_u32 s44, s45
    v_mfma_f32_32x32x16_bf16 v[144:159], a[100:103], v[200:203], v[144:159]
    s_cbranch_scc1 L_patch_4
L_patch_ret_4:
    ds_read_b64_tr_b16 a[96:97], v216 offset:32768
    v_exp_f32 v238, v13
    v_mfma_f32_32x32x16_bf16 v[160:175], a[104:107], v[200:203], v[160:175]
    ds_read_b64_tr_b16 a[98:99], v216 offset:34816
    v_add_f32 v229, v229, v237
    v_exp_f32 v233, v14
    v_add_f32 v230, v230, v238
    v_mfma_f32_32x32x16_bf16 v[176:191], a[108:111], v[200:203], v[176:191]
    ds_read_b64_tr_b16 a[100:101], v217 offset:32768
    v_cvt_pk_bf16_f32 v198, v237, v238
    v_exp_f32 v234, v15
    v_add_f32 v229, v229, v233
    v_mfma_f32_32x32x16_bf16 v[128:143], a[112:115], v[204:207], v[128:143]
    ds_read_b64_tr_b16 a[102:103], v217 offset:34816
    v_add_f32 v230, v230, v234
    v_cvt_pk_bf16_f32 v199, v233, v234
    v_add_f32 v229, v229, v230
    v_cmp_lt_f32 vcc, s52, v229
    v_mfma_f32_32x32x16_bf16 v[144:159], a[116:119], v[204:207], v[144:159]
    ds_read_b64_tr_b16 a[104:105], v218 offset:32768
    v_exp_f32 v231, v16
    v_exp_f32 v232, v17
    v_mfma_f32_32x32x16_bf16 v[160:175], a[120:123], v[204:207], v[160:175]
    s_cbranch_vccnz L_fb0_4
L_fb0_ret_4:
    ds_read_b64_tr_b16 a[106:107], v218 offset:34816
    v_add_f32 v225, v225, v229
    v_exp_f32 v233, v18
    v_mfma_f32_32x32x16_bf16 v[176:191], a[124:127], v[204:207], v[176:191]
    ds_read_b64_tr_b16 a[108:109], v219 offset:32768
    v_cvt_pk_bf16_f32 v200, v231, v232
    v_exp_f32 v234, v19
    s_waitcnt lgkmcnt(7)
    v_mfma_f32_32x32x16_bf16 v[0:15], a[64:67], a[0:3], v[32:47]
    ds_read_b64_tr_b16 a[110:111], v219 offset:34816
    v_add_f32 v231, v231, v233
    v_exp_f32 v235, v20
    v_add_f32 v232, v232, v234
    v_mfma_f32_32x32x16_bf16 v[0:15], a[68:71], a[4:7], v[0:15]
    ds_read_b64_tr_b16 a[112:113], v216 offset:36864
    v_cvt_pk_bf16_f32 v201, v233, v234
    v_exp_f32 v236, v21
    v_add_f32 v231, v231, v235
    v_mfma_f32_32x32x16_bf16 v[0:15], a[72:75], a[8:11], v[0:15]
    ds_read_b64_tr_b16 a[114:115], v216 offset:38912
    v_exp_f32 v237, v22
    v_add_f32 v232, v232, v236
    v_cvt_pk_bf16_f32 v202, v235, v236
    v_mfma_f32_32x32x16_bf16 v[0:15], a[76:79], a[12:15], v[0:15]
    ds_read_b64_tr_b16 a[116:117], v217 offset:36864
    v_exp_f32 v238, v23
    v_add_f32 v231, v231, v237
    v_exp_f32 v233, v24
    v_mfma_f32_32x32x16_bf16 v[0:15], a[80:83], a[16:19], v[0:15]
    ds_read_b64_tr_b16 a[118:119], v217 offset:38912
    v_add_f32 v232, v232, v238
    v_cvt_pk_bf16_f32 v203, v237, v238
    v_exp_f32 v234, v25
    v_mfma_f32_32x32x16_bf16 v[0:15], a[84:87], a[20:23], v[0:15]
    ds_read_b64_tr_b16 a[120:121], v218 offset:36864
    v_add_f32 v231, v231, v233
    v_exp_f32 v235, v26
    v_mfma_f32_32x32x16_bf16 v[0:15], a[88:91], a[24:27], v[0:15]
    ds_read_b64_tr_b16 a[122:123], v218 offset:38912
    v_readlane_b32 s48, v224, s47
    v_add_f32 v232, v232, v234
    v_cvt_pk_bf16_f32 v204, v233, v234
    v_exp_f32 v236, v27
    s_add_u32 s47, s47, 1
    v_mfma_f32_32x32x16_bf16 v[0:15], a[92:95], a[28:31], v[0:15]
    ds_read_b64_tr_b16 a[124:125], v219 offset:36864
    v_add_f32 v231, v231, v235
    v_exp_f32 v237, v28
    s_waitcnt lgkmcnt(7)
    v_mfma_f32_32x32x16_bf16 v[64:79], a[96:99], v[192:195], v[64:79]
    ds_read_b64_tr_b16 a[126:127], v219 offset:38912
    v_add_f32 v232, v232, v236
    v_cvt_pk_bf16_f32 v205, v235, v236
    v_exp_f32 v238, v29
    s_add_u32 m0, s51, 8192
    v_mfma_f32_32x32x16_bf16 v[80:95], a[100:103], v[192:195], v[80:95]
    buffer_load_dwordx4 v222, s[24:27], s49 offen nt lds
    v_add_f32 v231, v231, v237
    v_exp_f32 v233, v30
    v_mfma_f32_32x32x16_bf16 v[96:111], a[104:107], v[192:195], v[96:111]
    buffer_load_dwordx4 v223, s[24:27], s49 offen offset:1024 nt lds
    v_add_f32 v232, v232, v238
    v_cvt_pk_bf16_f32 v206, v237, v238
    s_add_u32 m0, s50, 16384
    v_mfma_f32_32x32x16_bf16 v[112:127], a[108:111], v[192:195], v[112:127]
    buffer_load_dwordx4 v220, s[20:23], s48 offen nt lds
    v_exp_f32 v234, v31
    s_waitcnt lgkmcnt(0)
    v_mfma_f32_32x32x16_bf16 v[64:79], a[112:115], v[196:199], v[64:79]
    v_add_f32 v231, v231, v233
    v_add_f32 v232, v232, v234
    v_cvt_pk_bf16_f32 v207, v233, v234
    v_add_f32 v231, v231, v232
    v_cmp_lt_f32 vcc, s52, v231
    v_mfma_f32_32x32x16_bf16 v[80:95], a[116:119], v[196:199], v[80:95]
    buffer_load_dwordx4 v221, s[20:23], s48 offen offset:1024 nt lds
    v_exp_f32 v229, v0
    v_mfma_f32_32x32x16_bf16 v[96:111], a[120:123], v[196:199], v[96:111]
    s_cbranch_vccnz L_fb1_4
L_fb1_ret_4:
    v_add_f32 v226, v226, v231
    v_exp_f32 v230, v1
    s_add_u32 s44, s44, 1
    s_cmp_ge_u32 s44, s43
    v_mfma_f32_32x32x16_bf16 v[112:127], a[124:127], v[196:199], v[112:127]
    s_cbranch_scc1 L_drain
L_body_5:
    v_mfma_f32_32x32x16_bf16 v[16:31], a[64:67], a[32:35], v[48:63]
    v_exp_f32 v233, v2
    v_cvt_pk_bf16_f32 v192, v229, v230
    v_exp_f32 v234, v3
    v_add_f32 v229, v229, v233
    v_mfma_f32_32x32x16_bf16 v[16:31], a[68:71], a[36:39], v[16:31]
    ds_read_b128 a[64:67], v208 offset:49152
    v_exp_f32 v235, v4
    v_add_f32 v230, v230, v234
    v_cvt_pk_bf16_f32 v193, v233, v234
    v_mfma_f32_32x32x16_bf16 v[16:31], a[72:75], a[40:43], v[16:31]
    ds_read_b128 a[68:71], v209 offset:49152
    v_exp_f32 v236, v5
    v_add_f32 v229, v229, v235
    v_mfma_f32_32x32x16_bf16 v[16:31], a[76:79], a[44:47], v[16:31]
    ds_read_b128 a[72:75], v210 offset:49152
    v_exp_f32 v237, v6
    v_add_f32 v230, v230, v236
    v_cvt_pk_bf16_f32 v194, v235, v236
    v_mfma_f32_32x32x16_bf16 v[16:31], a[80:83], a[48:51], v[16:31]
    ds_read_b128 a[76:79], v211 offset:49152
    v_exp_f32 v238, v7
    v_add_f32 v229, v229, v237
    v_exp_f32 v233, v8
    v_mfma_f32_32x32x16_bf16 v[16:31], a[84:87], a[52:55], v[16:31]
    ds_read_b128 a[80:83], v212 offset:49152
    v_add_f32 v230, v230, v238
    v_cvt_pk_bf16_f32 v195, v237, v238
    v_exp_f32 v234, v9
    v_mfma_f32_32x32x16_bf16 v[16:31], a[88:91], a[56:59], v[16:31]
    ds_read_b128 a[84:87], v213 offset:49152
    v_add_f32 v229, v229, v233
    v_exp_f32 v235, v10
    v_add_f32 v230, v230, v234
    v_mfma_f32_32x32x16_bf16 v[16:31], a[92:95], a[60:63], v[16:31]
    ds_read_b128 a[88:91], v214 offset:49152
    v_cvt_pk_bf16_f32 v196, v233, v234
    v_exp_f32 v236, v11
    v_add_f32 v229, v229, v235
    v_mfma_f32_32x32x16_bf16 v[128:143], a[96:99], v[200:203], v[128:143]
    ds_read_b128 a[92:95], v215 offset:49152
    v_exp_f32 v237, v12
    v_add_f32 v230, v230, v236
    v_cvt_pk_bf16_f32 v197, v235, v236
    s_cmp_eq_u32 s44, s45
    v_mfma_f32_32x32x16_bf16 v[144:159], a[100:103], v[200:203], v[144:159]
    s_cbranch_scc1 L_patch_5
L_patch_ret_5:
    ds_read_b64_tr_b16 a[96:97], v216 offset:40960
    v_exp_f32 v238, v13
    v_mfma_f32_32x32x16_bf16 v[160:175], a[104:107], v[200:203], v[160:175]
    ds_read_b64_tr_b16 a[98:99], v216 offset:43008
    v_add_f32 v229, v229, v237
    v_exp_f32 v233, v14
    v_add_f32 v230, v230, v238
    v_mfma_f32_32x32x16_bf16 v[176:191], a[108:111], v[200:203], v[176:191]
    ds_read_b64_tr_b16 a[100:101], v217 offset:40960
    v_cvt_pk_bf16_f32 v198, v237, v238
    v_exp_f32 v234, v15
    v_add_f32 v229, v229, v233
    v_mfma_f32_32x32x16_bf16 v[128:143], a[112:115], v[204:207], v[128:143]
    ds_read_b64_tr_b16 a[102:103], v217 offset:43008
    v_add_f32 v230, v230, v234
    v_cvt_pk_bf16_f32 v199, v233, v234
    v_add_f32 v229, v229, v230
    v_cmp_lt_f32 vcc, s52, v229
    v_mfma_f32_32x32x16_bf16 v[144:159], a[116:119], v[204:207], v[144:159]
    ds_read_b64_tr_b16 a[104:105], v218 offset:40960
    v_exp_f32 v231, v16
    v_exp_f32 v232, v17
    v_mfma_f32_32x32x16_bf16 v[160:175], a[120:123], v[204:207], v[160:175]
    s_cbranch_vccnz L_fb0_5
L_fb0_ret_5:
    ds_read_b64_tr_b16 a[106:107], v218 offset:43008
    v_add_f32 v225, v225, v229
    v_exp_f32 v233, v18
    v_mfma_f32_32x32x16_bf16 v[176:191], a[124:127], v[204:207], v[176:191]
    ds_read_b64_tr_b16 a[108:109], v219 offset:40960
    v_cvt_pk_bf16_f32 v200, v231, v232
    v_exp_f32 v234, v19
    s_waitcnt lgkmcnt(7)
    v_mfma_f32_32x32x16_bf16 v[0:15], a[64:67], a[0:3], v[32:47]
    ds_read_b64_tr_b16 a[110:111], v219 offset:43008
    v_add_f32 v231, v231, v233
    v_exp_f32 v235, v20
    v_add_f32 v232, v232, v234
    v_mfma_f32_32x32x16_bf16 v[0:15], a[68:71], a[4:7], v[0:15]
    ds_read_b64_tr_b16 a[112:113], v216 offset:45056
    v_cvt_pk_bf16_f32 v201, v233, v234
    v_exp_f32 v236, v21
    v_add_f32 v231, v231, v235
    v_mfma_f32_32x32x16_bf16 v[0:15], a[72:75], a[8:11], v[0:15]
    ds_read_b64_tr_b16 a[114:115], v216 offset:47104
    v_exp_f32 v237, v22
    v_add_f32 v232, v232, v236
    v_cvt_pk_bf16_f32 v202, v235, v236
    v_mfma_f32_32x32x16_bf16 v[0:15], a[76:79], a[12:15], v[0:15]
    ds_read_b64_tr_b16 a[116:117], v217 offset:45056
    v_exp_f32 v238, v23
    v_add_f32 v231, v231, v237
    v_exp_f32 v233, v24
    v_mfma_f32_32x32x16_bf16 v[0:15], a[80:83], a[16:19], v[0:15]
    ds_read_b64_tr_b16 a[118:119], v217 offset:47104
    v_add_f32 v232, v232, v238
    v_cvt_pk_bf16_f32 v203, v237, v238
    v_exp_f32 v234, v25
    v_mfma_f32_32x32x16_bf16 v[0:15], a[84:87], a[20:23], v[0:15]
    ds_read_b64_tr_b16 a[120:121], v218 offset:45056
    v_add_f32 v231, v231, v233
    v_exp_f32 v235, v26
    v_mfma_f32_32x32x16_bf16 v[0:15], a[88:91], a[24:27], v[0:15]
    ds_read_b64_tr_b16 a[122:123], v218 offset:47104
    v_readlane_b32 s49, v224, s47
    v_add_f32 v232, v232, v234
    v_cvt_pk_bf16_f32 v204, v233, v234
    v_exp_f32 v236, v27
    s_add_u32 s47, s47, 1
    v_mfma_f32_32x32x16_bf16 v[0:15], a[92:95], a[28:31], v[0:15]
    ds_read_b64_tr_b16 a[124:125], v219 offset:45056
    v_add_f32 v231, v231, v235
    v_exp_f32 v237, v28
    s_waitcnt lgkmcnt(7)
    v_mfma_f32_32x32x16_bf16 v[64:79], a[96:99], v[192:195], v[64:79]
    ds_read_b64_tr_b16 a[126:127], v219 offset:47104
    v_add_f32 v232, v232, v236
    v_cvt_pk_bf16_f32 v205, v235, v236
    v_exp_f32 v238, v29
    s_add_u32 m0, s51, 16384
    v_mfma_f32_32x32x16_bf16 v[80:95], a[100:103], v[192:195], v[80:95]
    buffer_load_dwordx4 v222, s[24:27], s48 offen nt lds
    v_add_f32 v231, v231, v237
    v_exp_f32 v233, v30
    v_mfma_f32_32x32x16_bf16 v[96:111], a[104:107], v[192:195], v[96:111]
    buffer_load_dwordx4 v223, s[24:27], s48 offen offset:1024 nt lds
    v_add_f32 v232, v232, v238
    v_cvt_pk_bf16_f32 v206, v237, v238
    s_add_u32 m0, s50, 24576
    v_mfma_f32_32x32x16_bf16 v[112:127], a[108:111], v[192:195], v[112:127]
    buffer_load_dwordx4 v220, s[20:23], s49 offen nt lds
    v_exp_f32 v234, v31
    s_waitcnt lgkmcnt(0)
    v_mfma_f32_32x32x16_bf16 v[64:79], a[112:115], v[196:199], v[64:79]
    v_add_f32 v231, v231, v233
    v_add_f32 v232, v232, v234
    v_cvt_pk_bf16_f32 v207, v233, v234
    v_add_f32 v231, v231, v232
    v_cmp_lt_f32 vcc, s52, v231
    v_mfma_f32_32x32x16_bf16 v[80:95], a[116:119], v[196:199], v[80:95]
    buffer_load_dwordx4 v221, s[20:23], s49 offen offset:1024 nt lds
    v_exp_f32 v229, v0
    v_mfma_f32_32x32x16_bf16 v[96:111], a[120:123], v[196:199], v[96:111]
    s_cbranch_vccnz L_fb1_5
L_fb1_ret_5:
    v_add_f32 v226, v226, v231
    v_exp_f32 v230, v1
    s_add_u32 s44, s44, 1
    s_cmp_ge_u32 s44, s43
    v_mfma_f32_32x32x16_bf16 v[112:127], a[124:127], v[196:199], v[112:127]
    s_cbranch_scc1 L_drain
L_body_6:
    s_waitcnt vmcnt(12)
    s_barrier
    v_mfma_f32_32x32x16_bf16 v[16:31], a[64:67], a[32:35], v[48:63]
    v_exp_f32 v233, v2
    v_cvt_pk_bf16_f32 v192, v229, v230
    v_exp_f32 v234, v3
    v_add_f32 v229, v229, v233
    v_mfma_f32_32x32x16_bf16 v[16:31], a[68:71], a[36:39], v[16:31]
    ds_read_b128 a[64:67], v208 offset:57344
    v_exp_f32 v235, v4
    v_add_f32 v230, v230, v234
    v_cvt_pk_bf16_f32 v193, v233, v234
    v_mfma_f32_32x32x16_bf16 v[16:31], a[72:75], a[40:43], v[16:31]
    ds_read_b128 a[68:71], v209 offset:57344
    v_exp_f32 v236, v5
    v_add_f32 v229, v229, v235
    v_mfma_f32_32x32x16_bf16 v[16:31], a[76:79], a[44:47], v[16:31]
    ds_read_b128 a[72:75], v210 offset:57344
    v_exp_f32 v237, v6
    v_add_f32 v230, v230, v236
    v_cvt_pk_bf16_f32 v194, v235, v236
    v_mfma_f32_32x32x16_bf16 v[16:31], a[80:83], a[48:51], v[16:31]
    ds_read_b128 a[76:79], v211 offset:57344
    v_exp_f32 v238, v7
    v_add_f32 v229, v229, v237
    v_exp_f32 v233, v8
    v_mfma_f32_32x32x16_bf16 v[16:31], a[84:87], a[52:55], v[16:31]
    ds_read_b128 a[80:83], v212 offset:57344
    v_add_f32 v230, v230, v238
    v_cvt_pk_bf16_f32 v195, v237, v238
    v_exp_f32 v234, v9
    v_mfma_f32_32x32x16_bf16 v[16:31], a[88:91], a[56:59], v[16:31]
    ds_read_b128 a[84:87], v213 offset:57344
    v_add_f32 v229, v229, v233
    v_exp_f32 v235, v10
    v_add_f32 v230, v230, v234
    v_mfma_f32_32x32x16_bf16 v[16:31], a[92:95], a[60:63], v[16:31]
    ds_read_b128 a[88:91], v214 offset:57344
    v_cvt_pk_bf16_f32 v196, v233, v234
    v_exp_f32 v236, v11
    v_add_f32 v229, v229, v235
    v_mfma_f32_32x32x16_bf16 v[128:143], a[96:99], v[200:203], v[128:143]
    ds_read_b128 a[92:95], v215 offset:57344
    v_exp_f32 v237, v12
    v_add_f32 v230, v230, v236
    v_cvt_pk_bf16_f32 v197, v235, v236
    s_cmp_eq_u32 s44, s45
    v_mfma_f32_32x32x16_bf16 v[144:159], a[100:103], v[200:203], v[144:159]
    s_cbranch_scc1 L_patch_6
L_patch_ret_6:
    ds_read_b64_tr_b16 a[96:97], v216 offset:49152
    v_exp_f32 v238, v13
    v_mfma_f32_32x32x16_bf16 v[160:175], a[104:107], v[200:203], v[160:175]
    ds_read_b64_tr_b16 a[98:99], v216 offset:51200
    v_add_f32 v229, v229, v237
    v_exp_f32 v233, v14
    v_add_f32 v230, v230, v238
    v_mfma_f32_32x32x16_bf16 v[176:191], a[108:111], v[200:203], v[176:191]
    ds_read_b64_tr_b16 a[100:101], v217 offset:49152
    v_cvt_pk_bf16_f32 v198, v237, v238
    v_exp_f32 v234, v15
    v_add_f32 v229, v229, v233
    v_mfma_f32_32x32x16_bf16 v[128:143], a[112:115], v[204:207], v[128:143]
    ds_read_b64_tr_b16 a[102:103], v217 offset:51200
    v_add_f32 v230, v230, v234
    v_cvt_pk_bf16_f32 v199, v233, v234
    v_add_f32 v229, v229, v230
    v_cmp_lt_f32 vcc, s52, v229
    v_mfma_f32_32x32x16_bf16 v[144:159], a[116:119], v[204:207], v[144:159]
    ds_read_b64_tr_b16 a[104:105], v218 offset:49152
    v_exp_f32 v231, v16
    v_exp_f32 v232, v17
    v_mfma_f32_32x32x16_bf16 v[160:175], a[120:123], v[204:207], v[160:175]
    s_cbranch_vccnz L_fb0_6
L_fb0_ret_6:
    ds_read_b64_tr_b16 a[106:107], v218 offset:51200
    v_add_f32 v225, v225, v229
    v_exp_f32 v233, v18
    v_mfma_f32_32x32x16_bf16 v[176:191], a[124:127], v[204:207], v[176:191]
    ds_read_b64_tr_b16 a[108:109], v219 offset:49152
    v_cvt_pk_bf16_f32 v200, v231, v232
    v_exp_f32 v234, v19
    s_waitcnt lgkmcnt(7)
    v_mfma_f32_32x32x16_bf16 v[0:15], a[64:67], a[0:3], v[32:47]
    ds_read_b64_tr_b16 a[110:111], v219 offset:51200
    v_add_f32 v231, v231, v233
    v_exp_f32 v235, v20
    v_add_f32 v232, v232, v234
    v_mfma_f32_32x32x16_bf16 v[0:15], a[68:71], a[4:7], v[0:15]
    ds_read_b64_tr_b16 a[112:113], v216 offset:53248
    v_cvt_pk_bf16_f32 v201, v233, v234
    v_exp_f32 v236, v21
    v_add_f32 v231, v231, v235
    v_mfma_f32_32x32x16_bf16 v[0:15], a[72:75], a[8:11], v[0:15]
    ds_read_b64_tr_b16 a[114:115], v216 offset:55296
    v_exp_f32 v237, v22
    v_add_f32 v232, v232, v236
    v_cvt_pk_bf16_f32 v202, v235, v236
    v_mfma_f32_32x32x16_bf16 v[0:15], a[76:79], a[12:15], v[0:15]
    ds_read_b64_tr_b16 a[116:117], v217 offset:53248
    v_exp_f32 v238, v23
    v_add_f32 v231, v231, v237
    v_exp_f32 v233, v24
    v_mfma_f32_32x32x16_bf16 v[0:15], a[80:83], a[16:19], v[0:15]
    ds_read_b64_tr_b16 a[118:119], v217 offset:55296
    v_add_f32 v232, v232, v238
    v_cvt_pk_bf16_f32 v203, v237, v238
    v_exp_f32 v234, v25
    v_mfma_f32_32x32x16_bf16 v[0:15], a[84:87], a[20:23], v[0:15]
    ds_read_b64_tr_b16 a[120:121], v218 offset:53248
    v_add_f32 v231, v231, v233
    v_exp_f32 v235, v26
    v_mfma_f32_32x32x16_bf16 v[0:15], a[88:91], a[24:27], v[0:15]
    ds_read_b64_tr_b16 a[122:123], v218 offset:55296
    v_readlane_b32 s48, v224, s47
    v_add_f32 v232, v232, v234
    v_cvt_pk_bf16_f32 v204, v233, v234
    v_exp_f32 v236, v27
    s_add_u32 s47, s47, 1
    v_mfma_f32_32x32x16_bf16 v[0:15], a[92:95], a[28:31], v[0:15]
    ds_read_b64_tr_b16 a[124:125], v219 offset:53248
    v_add_f32 v231, v231, v235
    v_exp_f32 v237, v28
    s_waitcnt lgkmcnt(7)
    v_mfma_f32_32x32x16_bf16 v[64:79], a[96:99], v[192:195], v[64:79]
    ds_read_b64_tr_b16 a[126:127], v219 offset:55296
    v_add_f32 v232, v232, v236
    v_cvt_pk_bf16_f32 v205, v235, v236
    v_exp_f32 v238, v29
    s_add_u32 m0, s51, 24576
    v_mfma_f32_32x32x16_bf16 v[80:95], a[100:103], v[192:195], v[80:95]
    buffer_load_dwordx4 v222, s[24:27], s49 offen nt lds
    v_add_f32 v231, v231, v237
    v_exp_f32 v233, v30
    v_mfma_f32_32x32x16_bf16 v[96:111], a[104:107], v[192:195], v[96:111]
    buffer_load_dwordx4 v223, s[24:27], s49 offen offset:1024 nt lds
    v_add_f32 v232, v232, v238
    v_cvt_pk_bf16_f32 v206, v237, v238
    s_add_u32 m0, s50, 32768
    v_mfma_f32_32x32x16_bf16 v[112:127], a[108:111], v[192:195], v[112:127]
    buffer_load_dwordx4 v220, s[20:23], s48 offen nt lds
    v_exp_f32 v234, v31
    s_waitcnt lgkmcnt(0)
    v_mfma_f32_32x32x16_bf16 v[64:79], a[112:115], v[196:199], v[64:79]
    v_add_f32 v231, v231, v233
    v_add_f32 v232, v232, v234
    v_cvt_pk_bf16_f32 v207, v233, v234
    v_add_f32 v231, v231, v232
    v_cmp_lt_f32 vcc, s52, v231
    v_mfma_f32_32x32x16_bf16 v[80:95], a[116:119], v[196:199], v[80:95]
    buffer_load_dwordx4 v221, s[20:23], s48 offen offset:1024 nt lds
    v_exp_f32 v229, v0
    v_mfma_f32_32x32x16_bf16 v[96:111], a[120:123], v[196:199], v[96:111]
    s_cbranch_vccnz L_fb1_6
L_fb1_ret_6:
    v_add_f32 v226, v226, v231
    v_exp_f32 v230, v1
    s_add_u32 s44, s44, 1
    s_cmp_ge_u32 s44, s43
    v_mfma_f32_32x32x16_bf16 v[112:127], a[124:127], v[196:199], v[112:127]
    s_cbranch_scc1 L_drain
L_body_7:
    v_mfma_f32_32x32x16_bf16 v[16:31], a[64:67], a[32:35], v[48:63]
    v_exp_f32 v233, v2
    v_cvt_pk_bf16_f32 v192, v229, v230
    v_exp_f32 v234, v3
    v_add_f32 v229, v229, v233
    v_mfma_f32_32x32x16_bf16 v[16:31], a[68:71], a[36:39], v[16:31]
    ds_read_b128 a[64:67], v208 offset:0
    v_exp_f32 v235, v4
    v_add_f32 v230, v230, v234
    v_cvt_pk_bf16_f32 v193, v233, v234
    v_mfma_f32_32x32x16_bf16 v[16:31], a[72:75], a[40:43], v[16:31]
    ds_read_b128 a[68:71], v209 offset:0
    v_exp_f32 v236, v5
    v_add_f32 v229, v229, v235
    v_mfma_f32_32x32x16_bf16 v[16:31], a[76:79], a[44:47], v[16:31]
    ds_read_b128 a[72:75], v210 offset:0
    v_exp_f32 v237, v6
    v_add_f32 v230, v230, v236
    v_cvt_pk_bf16_f32 v194, v235, v236
    v_mfma_f32_32x32x16_bf16 v[16:31], a[80:83], a[48:51], v[16:31]
    ds_read_b128 a[76:79], v211 offset:0
    v_exp_f32 v238, v7
    v_add_f32 v229, v229, v237
    v_exp_f32 v233, v8
    v_mfma_f32_32x32x16_bf16 v[16:31], a[84:87], a[52:55], v[16:31]
    ds_read_b128 a[80:83], v212 offset:0
    v_add_f32 v230, v230, v238
    v_cvt_pk_bf16_f32 v195, v237, v238
    v_exp_f32 v234, v9
    v_mfma_f32_32x32x16_bf16 v[16:31], a[88:91], a[56:59], v[16:31]
    ds_read_b128 a[84:87], v213 offset:0
    v_add_f32 v229, v229, v233
    v_exp_f32 v235, v10
    v_add_f32 v230, v230, v234
    v_mfma_f32_32x32x16_bf16 v[16:31], a[92:95], a[60:63], v[16:31]
    ds_read_b128 a[88:91], v214 offset:0
    v_cvt_pk_bf16_f32 v196, v233, v234
    v_exp_f32 v236, v11
    v_add_f32 v229, v229, v235
    v_mfma_f32_32x32x16_bf16 v[128:143], a[96:99], v[200:203], v[128:143]
    ds_read_b128 a[92:95], v215 offset:0
    v_exp_f32 v237, v12
    v_add_f32 v230, v230, v236
    v_cvt_pk_bf16_f32 v197, v235, v236
    s_cmp_eq_u32 s44, s45
    v_mfma_f32_32x32x16_bf16 v[144:159], a[100:103], v[200:203], v[144:159]
    s_cbranch_scc1 L_patch_7
L_patch_ret_7:
    ds_read_b64_tr_b16 a[96:97], v216 offset:57344
    v_exp_f32 v238, v13
    v_mfma_f32_32x32x16_bf16 v[160:175], a[104:107], v[200:203], v[160:175]
    ds_read_b64_tr_b16 a[98:99], v216 offset:59392
    v_add_f32 v229, v229, v237
    v_exp_f32 v233, v14
    v_add_f32 v230, v230, v238
    v_mfma_f32_32x32x16_bf16 v[176:191], a[108:111], v[200:203], v[176:191]
    ds_read_b64_tr_b16 a[100:101], v217 offset:57344
    v_cvt_pk_bf16_f32 v198, v237, v238
    v_exp_f32 v234, v15
    v_add_f32 v229, v229, v233
    v_mfma_f32_32x32x16_bf16 v[128:143], a[112:115], v[204:207], v[128:143]
    ds_read_b64_tr_b16 a[102:103], v217 offset:59392
    v_add_f32 v230, v230, v234
    v_cvt_pk_bf16_f32 v199, v233, v234
    v_add_f32 v229, v229, v230
    v_cmp_lt_f32 vcc, s52, v229
    v_mfma_f32_32x32x16_bf16 v[144:159], a[116:119], v[204:207], v[144:159]
    ds_read_b64_tr_b16 a[104:105], v218 offset:57344
    v_exp_f32 v231, v16
    v_exp_f32 v232, v17
    v_mfma_f32_32x32x16_bf16 v[160:175], a[120:123], v[204:207], v[160:175]
    s_cbranch_vccnz L_fb0_7
L_fb0_ret_7:
    ds_read_b64_tr_b16 a[106:107], v218 offset:59392
    v_add_f32 v225, v225, v229
    v_exp_f32 v233, v18
    v_mfma_f32_32x32x16_bf16 v[176:191], a[124:127], v[204:207], v[176:191]
    ds_read_b64_tr_b16 a[108:109], v219 offset:57344
    v_cvt_pk_bf16_f32 v200, v231, v232
    v_exp_f32 v234, v19
    s_waitcnt lgkmcnt(7)
    v_mfma_f32_32x32x16_bf16 v[0:15], a[64:67], a[0:3], v[32:47]
    ds_read_b64_tr_b16 a[110:111], v219 offset:59392
    v_add_f32 v231, v231, v233
    v_exp_f32 v235, v20
    v_add_f32 v232, v232, v234
    v_mfma_f32_32x32x16_bf16 v[0:15], a[68:71], a[4:7], v[0:15]
    ds_read_b64_tr_b16 a[112:113], v216 offset:61440
    v_cvt_pk_bf16_f32 v201, v233, v234
    v_exp_f32 v236, v21
    v_add_f32 v231, v231, v235
    v_mfma_f32_32x32x16_bf16 v[0:15], a[72:75], a[8:11], v[0:15]
    ds_read_b64_tr_b16 a[114:115], v216 offset:63488
    v_exp_f32 v237, v22
    v_add_f32 v232, v232, v236
    v_cvt_pk_bf16_f32 v202, v235, v236
    v_mfma_f32_32x32x16_bf16 v[0:15], a[76:79], a[12:15], v[0:15]
    ds_read_b64_tr_b16 a[116:117], v217 offset:61440
    v_exp_f32 v238, v23
    v_add_f32 v231, v231, v237
    v_exp_f32 v233, v24
    v_mfma_f32_32x32x16_bf16 v[0:15], a[80:83], a[16:19], v[0:15]
    ds_read_b64_tr_b16 a[118:119], v217 offset:63488
    v_add_f32 v232, v232, v238
    v_cvt_pk_bf16_f32 v203, v237, v238
    v_exp_f32 v234, v25
    v_mfma_f32_32x32x16_bf16 v[0:15], a[84:87], a[20:23], v[0:15]
    ds_read_b64_tr_b16 a[120:121], v218 offset:61440
    v_add_f32 v231, v231, v233
    v_exp_f32 v235, v26
    v_mfma_f32_32x32x16_bf16 v[0:15], a[88:91], a[24:27], v[0:15]
    ds_read_b64_tr_b16 a[122:123], v218 offset:63488
    v_readlane_b32 s49, v224, s47
    v_add_f32 v232, v232, v234
    v_cvt_pk_bf16_f32 v204, v233, v234
    v_exp_f32 v236, v27
    s_add_u32 s47, s47, 1
    v_mfma_f32_32x32x16_bf16 v[0:15], a[92:95], a[28:31], v[0:15]
    ds_read_b64_tr_b16 a[124:125], v219 offset:61440
    v_add_f32 v231, v231, v235
    v_exp_f32 v237, v28
    s_waitcnt lgkmcnt(7)
    v_mfma_f32_32x32x16_bf16 v[64:79], a[96:99], v[192:195], v[64:79]
    ds_read_b64_tr_b16 a[126:127], v219 offset:63488
    v_add_f32 v232, v232, v236
    v_cvt_pk_bf16_f32 v205, v235, v236
    v_exp_f32 v238, v29
    s_add_u32 m0, s51, 32768
    v_mfma_f32_32x32x16_bf16 v[80:95], a[100:103], v[192:195], v[80:95]
    buffer_load_dwordx4 v222, s[24:27], s48 offen nt lds
    v_add_f32 v231, v231, v237
    v_exp_f32 v233, v30
    v_mfma_f32_32x32x16_bf16 v[96:111], a[104:107], v[192:195], v[96:111]
    buffer_load_dwordx4 v223, s[24:27], s48 offen offset:1024 nt lds
    v_add_f32 v232, v232, v238
    v_cvt_pk_bf16_f32 v206, v237, v238
    s_add_u32 m0, s50, 40960
    v_mfma_f32_32x32x16_bf16 v[112:127], a[108:111], v[192:195], v[112:127]
    buffer_load_dwordx4 v220, s[20:23], s49 offen nt lds
    v_exp_f32 v234, v31
    s_waitcnt lgkmcnt(0)
    v_mfma_f32_32x32x16_bf16 v[64:79], a[112:115], v[196:199], v[64:79]
    v_add_f32 v231, v231, v233
    v_add_f32 v232, v232, v234
    v_cvt_pk_bf16_f32 v207, v233, v234
    v_add_f32 v231, v231, v232
    v_cmp_lt_f32 vcc, s52, v231
    v_mfma_f32_32x32x16_bf16 v[80:95], a[116:119], v[196:199], v[80:95]
    buffer_load_dwordx4 v221, s[20:23], s49 offen offset:1024 nt lds
    v_exp_f32 v229, v0
    v_mfma_f32_32x32x16_bf16 v[96:111], a[120:123], v[196:199], v[96:111]
    s_cbranch_vccnz L_fb1_7
L_fb1_ret_7:
    v_add_f32 v226, v226, v231
    v_exp_f32 v230, v1
    s_add_u32 s44, s44, 1
    s_cmp_ge_u32 s44, s43
    v_mfma_f32_32x32x16_bf16 v[112:127], a[124:127], v[196:199], v[112:127]
    s_cbranch_scc1 L_drain
    s_branch L_body_0
L_drain:
    v_mfma_f32_32x32x16_bf16 v[128:143], a[96:99], v[200:203], v[128:143]
    v_mov_b32 v246, v225
    v_mov_b32 v247, v226
    s_lshl_b32 s60, s83, 11
    s_lshl_b32 s61, s40, 4
    s_add_u32 s60, s60, s61
    v_permlane32_swap_b32 v225, v246
    v_permlane32_swap_b32 v226, v247
    v_lshlrev_b32 v248, 6, v239
    v_mfma_f32_32x32x16_bf16 v[144:159], a[100:103], v[200:203], v[144:159]
    v_mov_b32 v240, v227
    v_add_f32 v241, v225, v246
    v_mov_b32 v242, v228
    v_add_f32 v243, v226, v247
    s_add_u32 s60, s60, 0x1000000
    s_add_u32 s61, s61, 0x27000
    v_add_u32 v249, s61, v248
    s_mov_b32 exec_hi, 0
    buffer_store_dwordx4 v[240:243], v248, s[36:39], s60 offen sc1
    ds_write_b128 v249, v[240:243]
    s_mov_b64 exec, -1
    v_mfma_f32_32x32x16_bf16 v[160:175], a[104:107], v[200:203], v[160:175]
    s_lshl_b32 s60, s83, 16
    s_lshl_b32 s61, s40, 14
    s_add_u32 s60, s60, s61
    v_lshlrev_b32 v244, 4, v239
    s_lshl_b32 s62, s40, 4
    s_sub_u32 s62, s62, s85
    s_lshl_b32 s62, s62, 10
    s_add_u32 s62, s62, 0x20000
    v_mfma_f32_32x32x16_bf16 v[176:191], a[108:111], v[200:203], v[176:191]
    v_add_u32 v245, s62, v244
    v_cvt_pk_bf16_f32 v0, v64, v65
    v_cvt_pk_bf16_f32 v1, v66, v67
    v_cvt_pk_bf16_f32 v2, v68, v69
    v_cvt_pk_bf16_f32 v3, v70, v71
    v_cvt_pk_bf16_f32 v4, v72, v73
    v_cvt_pk_bf16_f32 v5, v74, v75
    v_cvt_pk_bf16_f32 v6, v76, v77
    v_mfma_f32_32x32x16_bf16 v[128:143], a[112:115], v[204:207], v[128:143]
    v_cvt_pk_bf16_f32 v7, v78, v79
    s_add_u32 s61, s60, 0
    s_bitcmp1_b32 s84, 0
    s_cbranch_scc1 L_own_0
    buffer_store_dwordx4 v[0:3], v244, s[36:39], s61 offen offset:0 sc1
    s_branch L_own_r0
L_own_0:
    ds_write_b128 v245, v[0:3] offset:0
L_own_r0:
    s_bitcmp1_b32 s84, 1
    s_cbranch_scc1 L_own_1
    buffer_store_dwordx4 v[4:7], v244, s[36:39], s61 offen offset:1024 sc1
    s_branch L_own_r1
L_own_1:
    ds_write_b128 v245, v[4:7] offset:1024
L_own_r1:
    v_cvt_pk_bf16_f32 v8, v80, v81
    v_cvt_pk_bf16_f32 v9, v82, v83
    v_cvt_pk_bf16_f32 v10, v84, v85
    v_cvt_pk_bf16_f32 v11, v86, v87
    v_mfma_f32_32x32x16_bf16 v[144:159], a[116:119], v[204:207], v[144:159]
    v_cvt_pk_bf16_f32 v12, v88, v89
    v_cvt_pk_bf16_f32 v13, v90, v91
    v_cvt_pk_bf16_f32 v14, v92, v93
    v_cvt_pk_bf16_f32 v15, v94, v95
    s_add_u32 s61, s60, 2048
    s_bitcmp1_b32 s84, 2
    s_cbranch_scc1 L_own_2
    buffer_store_dwordx4 v[8:11], v244, s[36:39], s61 offen offset:0 sc1
    s_branch L_own_r2
L_own_2:
    ds_write_b128 v245, v[8:11] offset:2048
L_own_r2:
    s_bitcmp1_b32 s84, 3
    s_cbranch_scc1 L_own_3
    buffer_store_dwordx4 v[12:15], v244, s[36:39], s61 offen offset:1024 sc1
    s_branch L_own_r3
L_own_3:
    ds_write_b128 v245, v[12:15] offset:3072
L_own_r3:
    v_cvt_pk_bf16_f32 v16, v96, v97
    v_mfma_f32_32x32x16_bf16 v[160:175], a[120:123], v[204:207], v[160:175]
    v_cvt_pk_bf16_f32 v17, v98, v99
    v_cvt_pk_bf16_f32 v18, v100, v101
    v_cvt_pk_bf16_f32 v19, v102, v103
    v_cvt_pk_bf16_f32 v20, v104, v105
    v_cvt_pk_bf16_f32 v21, v106, v107
    v_cvt_pk_bf16_f32 v22, v108, v109
    v_cvt_pk_bf16_f32 v23, v110, v111
    s_add_u32 s61, s60, 4096
    v_mfma_f32_32x32x16_bf16 v[176:191], a[124:127], v[204:207], v[176:191]
    s_bitcmp1_b32 s84, 4
    s_cbranch_scc1 L_own_4
    buffer_store_dwordx4 v[16:19], v244, s[36:39], s61 offen offset:0 sc1
    s_branch L_own_r4
L_own_4:
    ds_write_b128 v245, v[16:19] offset:4096
L_own_r4:
    s_bitcmp1_b32 s84, 5
    s_cbranch_scc1 L_own_5
    buffer_store_dwordx4 v[20:23], v244, s[36:39], s61 offen offset:1024 sc1
    s_branch L_own_r5
L_own_5:
    ds_write_b128 v245, v[20:23] offset:5120
L_own_r5:
    v_cvt_pk_bf16_f32 v24, v112, v113
    v_cvt_pk_bf16_f32 v25, v114, v115
    v_cvt_pk_bf16_f32 v26, v116, v117
    v_cvt_pk_bf16_f32 v27, v118, v119
    v_cvt_pk_bf16_f32 v28, v120, v121
    v_cvt_pk_bf16_f32 v29, v122, v123
    v_cvt_pk_bf16_f32 v30, v124, v125
    v_cvt_pk_bf16_f32 v31, v126, v127
    s_add_u32 s61, s60, 6144
    s_bitcmp1_b32 s84, 6
    s_cbranch_scc1 L_own_6
    buffer_store_dwordx4 v[24:27], v244, s[36:39], s61 offen offset:0 sc1
    s_branch L_own_r6
L_own_6:
    ds_write_b128 v245, v[24:27] offset:6144
L_own_r6:
    s_bitcmp1_b32 s84, 7
    s_cbranch_scc1 L_own_7
    buffer_store_dwordx4 v[28:31], v244, s[36:39], s61 offen offset:1024 sc1
    s_branch L_own_r7
L_own_7:
    ds_write_b128 v245, v[28:31] offset:7168
L_own_r7:
    s_nop 7
    v_cvt_pk_bf16_f32 v32, v128, v129
    v_cvt_pk_bf16_f32 v33, v130, v131
    v_cvt_pk_bf16_f32 v34, v132, v133
    v_cvt_pk_bf16_f32 v35, v134, v135
    v_cvt_pk_bf16_f32 v36, v136, v137
    v_cvt_pk_bf16_f32 v37, v138, v139
    v_cvt_pk_bf16_f32 v38, v140, v141
    v_cvt_pk_bf16_f32 v39, v142, v143
    s_add_u32 s61, s60, 8192
    s_bitcmp1_b32 s84, 8
    s_cbranch_scc1 L_own_8
    buffer_store_dwordx4 v[32:35], v244, s[36:39], s61 offen offset:0 sc1
    s_branch L_own_r8
L_own_8:
    ds_write_b128 v245, v[32:35] offset:8192
L_own_r8:
    s_bitcmp1_b32 s84, 9
    s_cbranch_scc1 L_own_9
    buffer_store_dwordx4 v[36:39], v244, s[36:39], s61 offen offset:1024 sc1
    s_branch L_own_r9
L_own_9:
    ds_write_b128 v245, v[36:39] offset:9216
L_own_r9:
    v_cvt_pk_bf16_f32 v40, v144, v145
    v_cvt_pk_bf16_f32 v41, v146, v147
    v_cvt_pk_bf16_f32 v42, v148, v149
    v_cvt_pk_bf16_f32 v43, v150, v151
    v_cvt_pk_bf16_f32 v44, v152, v153
    v_cvt_pk_bf16_f32 v45, v154, v155
    v_cvt_pk_bf16_f32 v46, v156, v157
    v_cvt_pk_bf16_f32 v47, v158, v159
    s_add_u32 s61, s60, 10240
    s_bitcmp1_b32 s84, 10
    s_cbranch_scc1 L_own_10
    buffer_store_dwordx4 v[40:43], v244, s[36:39], s61 offen offset:0 sc1
    s_branch L_own_r10
L_own_10:
    ds_write_b128 v245, v[40:43] offset:10240
L_own_r10:
    s_bitcmp1_b32 s84, 11
    s_cbranch_scc1 L_own_11
    buffer_store_dwordx4 v[44:47], v244, s[36:39], s61 offen offset:1024 sc1
    s_branch L_own_r11
L_own_11:
    ds_write_b128 v245, v[44:47] offset:11264
L_own_r11:
    v_cvt_pk_bf16_f32 v48, v160, v161
    v_cvt_pk_bf16_f32 v49, v162, v163
    v_cvt_pk_bf16_f32 v50, v164, v165
    v_cvt_pk_bf16_f32 v51, v166, v167
    v_cvt_pk_bf16_f32 v52, v168, v169
    v_cvt_pk_bf16_f32 v53, v170, v171
    v_cvt_pk_bf16_f32 v54, v172, v173
    v_cvt_pk_bf16_f32 v55, v174, v175
    s_add_u32 s61, s60, 12288
    s_bitcmp1_b32 s84, 12
    s_cbranch_scc1 L_own_12
    buffer_store_dwordx4 v[48:51], v244, s[36:39], s61 offen offset:0 sc1
    s_branch L_own_r12
L_own_12:
    ds_write_b128 v245, v[48:51] offset:12288
L_own_r12:
    s_bitcmp1_b32 s84, 13
    s_cbranch_scc1 L_own_13
    buffer_store_dwordx4 v[52:55], v244, s[36:39], s61 offen offset:1024 sc1
    s_branch L_own_r13
L_own_13:
    ds_write_b128 v245, v[52:55] offset:13312
L_own_r13:
    v_cvt_pk_bf16_f32 v56, v176, v177
    v_cvt_pk_bf16_f32 v57, v178, v179
    v_cvt_pk_bf16_f32 v58, v180, v181
    v_cvt_pk_bf16_f32 v59, v182, v183
    v_cvt_pk_bf16_f32 v60, v184, v185
    v_cvt_pk_bf16_f32 v61, v186, v187
    v_cvt_pk_bf16_f32 v62, v188, v189
    v_cvt_pk_bf16_f32 v63, v190, v191
    s_add_u32 s61, s60, 14336
    s_bitcmp1_b32 s84, 14
    s_cbranch_scc1 L_own_14
    buffer_store_dwordx4 v[56:59], v244, s[36:39], s61 offen offset:0 sc1
    s_branch L_own_r14
L_own_14:
    ds_write_b128 v245, v[56:59] offset:14336
L_own_r14:
    s_bitcmp1_b32 s84, 15
    s_cbranch_scc1 L_own_15
    buffer_store_dwordx4 v[60:63], v244, s[36:39], s61 offen offset:1024 sc1
    s_branch L_own_r15
L_own_15:
    ds_write_b128 v245, v[60:63] offset:15360
L_own_r15:
    v_lshlrev_b32 v206, 4, v239
    v_and_b32 v207, 31, v239
    v_lshlrev_b32 v208, 8, v207
    v_lshl_add_u32 v208, v255, 2, v208
    v_lshlrev_b32 v207, 6, v207
    v_lshlrev_b32 v210, 3, v239
    v_cmp_gt_u32 vcc, s82, v239
    s_mov_b64 s[56:57], vcc
    s_lshl_b32 s75, s80, 2
    s_add_u32 s75, s75, s41
    s_lshl_b32 s75, s75, 11
    s_add_u32 s75, s75, 0x1180000
    s_lshl_b32 s60, s3, 3
    s_add_u32 s60, s60, s75
    s_mov_b32 s55, 200000
    v_mov_b32 v200, 0x27ff0

    s_waitcnt vmcnt(0)
    s_cmp_lg_u32 s40, 0
    s_cbranch_scc1 L_fc_nz
    v_readfirstlane_b32 s54, v250
    s_cmp_lg_u32 s54, 0
    s_cbranch_scc1 L_fc_havenonce

L_fc_npoll:
    buffer_load_dwordx2 v[250:251], off, s[32:35], 0 sc1
    s_waitcnt vmcnt(0)
    v_readfirstlane_b32 s54, v250
    s_sub_u32 s55, s55, 1
    s_cmp_eq_u32 s55, 1
    s_cbranch_scc1 L_fc_havenonce
    s_cmp_eq_u32 s54, 0
    s_cbranch_scc1 L_fc_npoll

L_fc_havenonce:
    ds_write_b64 v200, v[250:251]
L_fc_nz:
    s_waitcnt lgkmcnt(0)
    s_barrier
    s_cmp_eq_u32 s40, 0
    s_cselect_b64 exec, 1, 0
    s_cbranch_scc0 L_fc_noflag
    buffer_store_dwordx2 v[250:251], off, s[36:39], s60 sc1

L_fc_noflag:
    s_mov_b64 exec, -1
    ds_read_b64 v[214:215], v200

    s_mov_b32 s32, s14
    s_and_b32 s33, s15, 0xffff
    s_mov_b32 s34, 0x200000
    s_mov_b32 s35, 0x20000

    s_waitcnt lgkmcnt(0)
    v_readfirstlane_b32 s54, v214
    v_readfirstlane_b32 s46, v215

    s_cmp_ge_u32 s86, s87
    s_cbranch_scc1 L_fc_end

L_fc_outer:
    s_sub_u32 s69, s87, s86
    s_min_u32 s69, s69, 3
    s_lshl_b32 s70, s86, 10
    s_lshr_b32 s60, s86, 3
    s_lshl_b32 s72, s60, 3
    s_mov_b64 s[62:63], 0
    s_lshl_b32 s42, s60, 8
    s_add_u32 s42, s42, s75
    s_add_u32 s52, s86, s69
    s_sub_u32 s52, s52, 1
    s_lshr_b32 s52, s52, 3
    s_lshl_b32 s52, s52, 8
    s_add_u32 s52, s52, s75

    s_add_u32 s61, s86, 1
    s_lshr_b32 s61, s61, 3
    s_cmp_lg_u32 s61, s60
    s_cselect_b64 s[66:67], -1, 0

    s_add_u32 s61, s86, 2
    s_lshr_b32 s61, s61, 3
    s_cmp_lg_u32 s61, s60
    s_cselect_b64 s[76:77], -1, 0

    s_cmp_lt_u32 s82, 3
    s_cbranch_scc1 L_fc_zero
    s_sub_u32 s60, s86, s85
    s_lshl_b32 s60, s60, 10
    s_add_u32 s60, s60, 0x20000
    v_add_u32 v212, s60, v206
    s_add_u32 s60, s72, 0x27000
    v_add_u32 v213, s60, v207
    ds_read_b128 v[0:3], v212
    ds_read_b128 v[4:7], v212 offset:1024
    ds_read_b128 v[8:11], v212 offset:2048
    ds_read_b64 v[96:97], v213
    ds_read_b64 v[98:99], v213 offset:8
    s_bitset1_b64 s[62:63], s3
    s_waitcnt lgkmcnt(0)
    v_mov_b32 v192, v96
    v_mov_b32 v194, v97
    v_mov_b32 v193, v98
    v_mov_b32 v195, v99

    v_lshlrev_b32 v160, 16, v0
    v_and_b32 v161, 0xffff0000, v0

    v_lshlrev_b32 v162, 16, v1
    v_and_b32 v163, 0xffff0000, v1

    v_lshlrev_b32 v164, 16, v2
    v_and_b32 v165, 0xffff0000, v2

    v_lshlrev_b32 v166, 16, v3
    v_and_b32 v167, 0xffff0000, v3

    v_lshlrev_b32 v168, 16, v4
    v_and_b32 v169, 0xffff0000, v4

    v_lshlrev_b32 v170, 16, v5
    v_and_b32 v171, 0xffff0000, v5

    v_lshlrev_b32 v172, 16, v6
    v_and_b32 v173, 0xffff0000, v6

    v_lshlrev_b32 v174, 16, v7
    v_and_b32 v175, 0xffff0000, v7

    v_lshlrev_b32 v176, 16, v8
    v_and_b32 v177, 0xffff0000, v8

    v_lshlrev_b32 v178, 16, v9
    v_and_b32 v179, 0xffff0000, v9

    v_lshlrev_b32 v180, 16, v10
    v_and_b32 v181, 0xffff0000, v10

    v_lshlrev_b32 v182, 16, v11
    v_and_b32 v183, 0xffff0000, v11

    s_branch L_fc_init
L_fc_zero:
    v_mov_b32 v192, 0xff800000
    v_mov_b32 v194, 0
    v_mov_b32 v193, 0xff800000
    v_mov_b32 v195, 0
    v_mov_b32 v160, 0
    v_mov_b32 v161, 0
    v_mov_b32 v162, 0
    v_mov_b32 v163, 0
    v_mov_b32 v164, 0
    v_mov_b32 v165, 0
    v_mov_b32 v166, 0
    v_mov_b32 v167, 0
    v_mov_b32 v168, 0
    v_mov_b32 v169, 0
    v_mov_b32 v170, 0
    v_mov_b32 v171, 0
    v_mov_b32 v172, 0
    v_mov_b32 v173, 0
    v_mov_b32 v174, 0
    v_mov_b32 v175, 0
    v_mov_b32 v176, 0
    v_mov_b32 v177, 0
    v_mov_b32 v178, 0
    v_mov_b32 v179, 0
    v_mov_b32 v180, 0
    v_mov_b32 v181, 0
    v_mov_b32 v182, 0
    v_mov_b32 v183, 0
L_fc_init:
    s_add_u32 s72, s72, 0x1000000
L_fc_poll:
    buffer_load_dwordx2 v[214:215], v210, s[36:39], s75 offen sc1
    s_waitcnt vmcnt(0)
    v_cmp_eq_u32 vcc, s54, v214
    s_and_b64 s[64:65], vcc, s[56:57]
    v_cmp_eq_u32 vcc, s46, v215
    s_and_b64 s[64:65], vcc, s[64:65]
    s_andn2_b64 s[64:65], s[64:65], s[62:63]
    s_cbranch_scc1 L_fc_go
    s_sleep 1
    s_sub_u32 s55, s55, 1
    s_cmp_lg_u32 s55, 0
    s_cbranch_scc1 L_fc_poll
    s_branch L_fc_store

L_fc_go:
    s_mov_b64 s[78:79], s[64:65]
    v_mov_b32 v196, v192
    v_mov_b32 v197, v193

    s_ff1_i32_b64 s60, s[64:65]
    s_bitset0_b64 s[64:65], s60
    s_add_u32 s60, s60, s53
    s_lshl_b32 s48, s60, 16
    s_lshl_b32 s60, s60, 11
    s_add_u32 s60, s60, s72
    s_add_u32 s48, s48, s70
    s_mov_b32 s68, 1
    buffer_load_dwordx4 v[96:99], v207, s[36:39], s60 offen sc1

    s_cmp_eq_u64 s[64:65], 0
    s_cbranch_scc1 L_fc_taken

    s_ff1_i32_b64 s60, s[64:65]
    s_bitset0_b64 s[64:65], s60
    s_add_u32 s60, s60, s53
    s_lshl_b32 s49, s60, 16
    s_lshl_b32 s60, s60, 11
    s_add_u32 s60, s60, s72
    s_add_u32 s49, s49, s70
    s_mov_b32 s68, 2
    buffer_load_dwordx4 v[100:103], v207, s[36:39], s60 offen sc1

    s_cmp_eq_u64 s[64:65], 0
    s_cbranch_scc1 L_fc_taken

    s_ff1_i32_b64 s60, s[64:65]
    s_bitset0_b64 s[64:65], s60
    s_add_u32 s60, s60, s53
    s_lshl_b32 s50, s60, 16
    s_lshl_b32 s60, s60, 11
    s_add_u32 s60, s60, s72
    s_add_u32 s50, s50, s70
    s_mov_b32 s68, 3
    buffer_load_dwordx4 v[104:107], v207, s[36:39], s60 offen sc1

    s_cmp_eq_u64 s[64:65], 0
    s_cbranch_scc1 L_fc_taken

    s_ff1_i32_b64 s60, s[64:65]
    s_bitset0_b64 s[64:65], s60
    s_add_u32 s60, s60, s53
    s_lshl_b32 s51, s60, 16
    s_lshl_b32 s60, s60, 11
    s_add_u32 s60, s60, s72
    s_add_u32 s51, s51, s70
    s_mov_b32 s68, 4
    buffer_load_dwordx4 v[108:111], v207, s[36:39], s60 offen sc1

    s_cmp_eq_u64 s[64:65], 0
    s_cbranch_scc1 L_fc_taken

    s_ff1_i32_b64 s60, s[64:65]
    s_bitset0_b64 s[64:65], s60
    s_add_u32 s60, s60, s53
    s_lshl_b32 s71, s60, 16
    s_lshl_b32 s60, s60, 11
    s_add_u32 s60, s60, s72
    s_add_u32 s71, s71, s70
    s_mov_b32 s68, 5
    buffer_load_dwordx4 v[112:115], v207, s[36:39], s60 offen sc1

    s_cmp_eq_u64 s[64:65], 0
    s_cbranch_scc1 L_fc_taken

    s_ff1_i32_b64 s60, s[64:65]
    s_bitset0_b64 s[64:65], s60
    s_add_u32 s60, s60, s53
    s_lshl_b32 s73, s60, 16
    s_lshl_b32 s60, s60, 11
    s_add_u32 s60, s60, s72
    s_add_u32 s73, s73, s70
    s_mov_b32 s68, 6
    buffer_load_dwordx4 v[116:119], v207, s[36:39], s60 offen sc1

    s_cmp_eq_u64 s[64:65], 0
    s_cbranch_scc1 L_fc_taken

    s_ff1_i32_b64 s60, s[64:65]
    s_bitset0_b64 s[64:65], s60
    s_add_u32 s60, s60, s53
    s_lshl_b32 s44, s60, 16
    s_lshl_b32 s60, s60, 11
    s_add_u32 s60, s60, s72
    s_add_u32 s44, s44, s70
    s_mov_b32 s68, 7
    buffer_load_dwordx4 v[120:123], v207, s[36:39], s60 offen sc1

    s_cmp_eq_u64 s[64:65], 0
    s_cbranch_scc1 L_fc_taken

    s_ff1_i32_b64 s60, s[64:65]
    s_bitset0_b64 s[64:65], s60
    s_add_u32 s60, s60, s53
    s_lshl_b32 s45, s60, 16
    s_lshl_b32 s60, s60, 11
    s_add_u32 s60, s60, s72
    s_add_u32 s45, s45, s70
    s_mov_b32 s68, 8
    buffer_load_dwordx4 v[124:127], v207, s[36:39], s60 offen sc1

L_fc_taken:
    s_andn2_b64 s[78:79], s[78:79], s[64:65]
    s_or_b64 s[62:63], s[62:63], s[78:79]
    s_cmp_eq_u32 s69, 2
    s_cbranch_scc1 L_fc_r2
    s_cmp_eq_u32 s69, 3
    s_cbranch_scc1 L_fc_r3

L_fc_r1:
    s_cmp_le_u32 s68, 7
    s_cbranch_scc1 L_fc_r1_p7

    buffer_load_dwordx4 v[84:87], v206, s[36:39], s45 offen offset:0 sc1
L_fc_r1_p7:
    s_cmp_le_u32 s68, 6
    s_cbranch_scc1 L_fc_r1_p6

    buffer_load_dwordx4 v[72:75], v206, s[36:39], s44 offen offset:0 sc1
L_fc_r1_p6:
    s_cmp_le_u32 s68, 5
    s_cbranch_scc1 L_fc_r1_p5

    buffer_load_dwordx4 v[60:63], v206, s[36:39], s73 offen offset:0 sc1
L_fc_r1_p5:
    s_cmp_le_u32 s68, 4
    s_cbranch_scc1 L_fc_r1_p4

    s_cmp_gt_u32 s68, 7
    s_cbranch_scc1 L_fc_r1_pd

    buffer_load_dwordx4 v[48:51], v206, s[36:39], s71 offen offset:0 sc1
L_fc_r1_p4:
    s_cmp_le_u32 s68, 3
    s_cbranch_scc1 L_fc_r1_p3

    s_cmp_gt_u32 s68, 6
    s_cbranch_scc1 L_fc_r1_pd

    buffer_load_dwordx4 v[36:39], v206, s[36:39], s51 offen offset:0 sc1
L_fc_r1_p3:
    s_cmp_le_u32 s68, 2
    s_cbranch_scc1 L_fc_r1_p2

    s_cmp_gt_u32 s68, 5
    s_cbranch_scc1 L_fc_r1_pd

    buffer_load_dwordx4 v[24:27], v206, s[36:39], s50 offen offset:0 sc1
L_fc_r1_p2:
    s_cmp_le_u32 s68, 1
    s_cbranch_scc1 L_fc_r1_p1

    s_cmp_gt_u32 s68, 4
    s_cbranch_scc1 L_fc_r1_pd

    buffer_load_dwordx4 v[12:15], v206, s[36:39], s49 offen offset:0 sc1
L_fc_r1_p1:
    s_cmp_le_u32 s68, 0
    s_cbranch_scc1 L_fc_r1_p0

    s_cmp_gt_u32 s68, 3
    s_cbranch_scc1 L_fc_r1_pd

    buffer_load_dwordx4 v[0:3], v206, s[36:39], s48 offen offset:0 sc1
L_fc_r1_p0:
L_fc_r1_pd:
    s_cmp_eq_u32 s68, 1
    s_cbranch_scc0 L_fc_r1_w1
    s_waitcnt vmcnt(1)

L_fc_r1_w1:
    s_cmp_eq_u32 s68, 2
    s_cbranch_scc0 L_fc_r1_w2
    s_waitcnt vmcnt(2)

L_fc_r1_w2:
    s_waitcnt vmcnt(3)
    v_max_f32 v196, v196, v96
    s_cmp_le_u32 s68, 1
    s_cbranch_scc1 L_fc_r1_max

    v_max_f32 v196, v196, v100
    s_cmp_le_u32 s68, 2
    s_cbranch_scc1 L_fc_r1_max

    v_max_f32 v196, v196, v104
    s_cmp_le_u32 s68, 3
    s_cbranch_scc1 L_fc_r1_max

    v_max_f32 v196, v196, v108
    s_cmp_le_u32 s68, 4
    s_cbranch_scc1 L_fc_r1_max

    v_max_f32 v196, v196, v112
    s_cmp_le_u32 s68, 5
    s_cbranch_scc1 L_fc_r1_max

    v_max_f32 v196, v196, v116
    s_cmp_le_u32 s68, 6
    s_cbranch_scc1 L_fc_r1_max

    v_max_f32 v196, v196, v120
    s_cmp_le_u32 s68, 7
    s_cbranch_scc1 L_fc_r1_max

    v_max_f32 v196, v196, v124
L_fc_r1_max:
    v_sub_f32 v198, v192, v196
    v_exp_f32 v198, v198
    v_mov_b32 v192, v196

    v_mul_f32 v194, v194, v198
    v_mul_f32 v160, v160, v198
    v_mul_f32 v161, v161, v198
    v_mul_f32 v162, v162, v198
    v_mul_f32 v163, v163, v198
    v_mul_f32 v164, v164, v198
    v_mul_f32 v165, v165, v198
    v_mul_f32 v166, v166, v198
    v_mul_f32 v167, v167, v198
    s_cmp_le_u32 s68, 7
    s_cbranch_scc1 L_fc_r1_u7

    buffer_load_dwordx4 v[48:51], v206, s[36:39], s71 offen offset:0 sc1
    v_sub_f32 v204, v124, v196
    v_exp_f32 v204, v204
    s_nop 0
    v_fmac_f32 v194, v204, v125
    s_waitcnt vmcnt(3)
    v_lshlrev_b32 v200, 16, v84
    v_and_b32 v201, 0xffff0000, v84
    v_fmac_f32 v160, v204, v200
    v_fmac_f32 v161, v204, v201

    v_lshlrev_b32 v202, 16, v85
    v_and_b32 v203, 0xffff0000, v85
    v_fmac_f32 v162, v204, v202
    v_fmac_f32 v163, v204, v203

    v_lshlrev_b32 v200, 16, v86
    v_and_b32 v201, 0xffff0000, v86
    v_fmac_f32 v164, v204, v200
    v_fmac_f32 v165, v204, v201

    v_lshlrev_b32 v202, 16, v87
    v_and_b32 v203, 0xffff0000, v87
    v_fmac_f32 v166, v204, v202
    v_fmac_f32 v167, v204, v203

L_fc_r1_u7:
    s_cmp_le_u32 s68, 6
    s_cbranch_scc1 L_fc_r1_u6

    buffer_load_dwordx4 v[36:39], v206, s[36:39], s51 offen offset:0 sc1
    v_sub_f32 v204, v120, v196
    v_exp_f32 v204, v204
    s_nop 0
    v_fmac_f32 v194, v204, v121
    s_waitcnt vmcnt(3)
    v_lshlrev_b32 v200, 16, v72
    v_and_b32 v201, 0xffff0000, v72
    v_fmac_f32 v160, v204, v200
    v_fmac_f32 v161, v204, v201

    v_lshlrev_b32 v202, 16, v73
    v_and_b32 v203, 0xffff0000, v73
    v_fmac_f32 v162, v204, v202
    v_fmac_f32 v163, v204, v203

    v_lshlrev_b32 v200, 16, v74
    v_and_b32 v201, 0xffff0000, v74
    v_fmac_f32 v164, v204, v200
    v_fmac_f32 v165, v204, v201

    v_lshlrev_b32 v202, 16, v75
    v_and_b32 v203, 0xffff0000, v75
    v_fmac_f32 v166, v204, v202
    v_fmac_f32 v167, v204, v203

L_fc_r1_u6:
    s_cmp_le_u32 s68, 5
    s_cbranch_scc1 L_fc_r1_u5

    buffer_load_dwordx4 v[24:27], v206, s[36:39], s50 offen offset:0 sc1
    v_sub_f32 v204, v116, v196
    v_exp_f32 v204, v204
    s_nop 0
    v_fmac_f32 v194, v204, v117
    s_waitcnt vmcnt(3)
    v_lshlrev_b32 v200, 16, v60
    v_and_b32 v201, 0xffff0000, v60
    v_fmac_f32 v160, v204, v200
    v_fmac_f32 v161, v204, v201

    v_lshlrev_b32 v202, 16, v61
    v_and_b32 v203, 0xffff0000, v61
    v_fmac_f32 v162, v204, v202
    v_fmac_f32 v163, v204, v203

    v_lshlrev_b32 v200, 16, v62
    v_and_b32 v201, 0xffff0000, v62
    v_fmac_f32 v164, v204, v200
    v_fmac_f32 v165, v204, v201

    v_lshlrev_b32 v202, 16, v63
    v_and_b32 v203, 0xffff0000, v63
    v_fmac_f32 v166, v204, v202
    v_fmac_f32 v167, v204, v203

L_fc_r1_u5:
    s_cmp_le_u32 s68, 4
    s_cbranch_scc1 L_fc_r1_u4

    buffer_load_dwordx4 v[12:15], v206, s[36:39], s49 offen offset:0 sc1
    v_sub_f32 v204, v112, v196
    v_exp_f32 v204, v204
    s_nop 0
    v_fmac_f32 v194, v204, v113
    s_waitcnt vmcnt(3)
    v_lshlrev_b32 v200, 16, v48
    v_and_b32 v201, 0xffff0000, v48
    v_fmac_f32 v160, v204, v200
    v_fmac_f32 v161, v204, v201

    v_lshlrev_b32 v202, 16, v49
    v_and_b32 v203, 0xffff0000, v49
    v_fmac_f32 v162, v204, v202
    v_fmac_f32 v163, v204, v203

    v_lshlrev_b32 v200, 16, v50
    v_and_b32 v201, 0xffff0000, v50
    v_fmac_f32 v164, v204, v200
    v_fmac_f32 v165, v204, v201

    v_lshlrev_b32 v202, 16, v51
    v_and_b32 v203, 0xffff0000, v51
    v_fmac_f32 v166, v204, v202
    v_fmac_f32 v167, v204, v203

L_fc_r1_u4:
    s_cmp_le_u32 s68, 3
    s_cbranch_scc1 L_fc_r1_u3

    buffer_load_dwordx4 v[0:3], v206, s[36:39], s48 offen offset:0 sc1
    v_sub_f32 v204, v108, v196
    v_exp_f32 v204, v204
    s_nop 0
    v_fmac_f32 v194, v204, v109
    s_waitcnt vmcnt(3)
    v_lshlrev_b32 v200, 16, v36
    v_and_b32 v201, 0xffff0000, v36
    v_fmac_f32 v160, v204, v200
    v_fmac_f32 v161, v204, v201

    v_lshlrev_b32 v202, 16, v37
    v_and_b32 v203, 0xffff0000, v37
    v_fmac_f32 v162, v204, v202
    v_fmac_f32 v163, v204, v203

    v_lshlrev_b32 v200, 16, v38
    v_and_b32 v201, 0xffff0000, v38
    v_fmac_f32 v164, v204, v200
    v_fmac_f32 v165, v204, v201

    v_lshlrev_b32 v202, 16, v39
    v_and_b32 v203, 0xffff0000, v39
    v_fmac_f32 v166, v204, v202
    v_fmac_f32 v167, v204, v203

L_fc_r1_u3:
    s_cmp_le_u32 s68, 2
    s_cbranch_scc1 L_fc_r1_u2

    v_sub_f32 v204, v104, v196
    v_exp_f32 v204, v204
    s_nop 0
    v_fmac_f32 v194, v204, v105
    s_waitcnt vmcnt(2)
    v_lshlrev_b32 v200, 16, v24
    v_and_b32 v201, 0xffff0000, v24
    v_fmac_f32 v160, v204, v200
    v_fmac_f32 v161, v204, v201

    v_lshlrev_b32 v202, 16, v25
    v_and_b32 v203, 0xffff0000, v25
    v_fmac_f32 v162, v204, v202
    v_fmac_f32 v163, v204, v203

    v_lshlrev_b32 v200, 16, v26
    v_and_b32 v201, 0xffff0000, v26
    v_fmac_f32 v164, v204, v200
    v_fmac_f32 v165, v204, v201

    v_lshlrev_b32 v202, 16, v27
    v_and_b32 v203, 0xffff0000, v27
    v_fmac_f32 v166, v204, v202
    v_fmac_f32 v167, v204, v203

L_fc_r1_u2:
    s_cmp_le_u32 s68, 1
    s_cbranch_scc1 L_fc_r1_u1

    v_sub_f32 v204, v100, v196
    v_exp_f32 v204, v204
    s_nop 0
    v_fmac_f32 v194, v204, v101
    s_waitcnt vmcnt(1)
    v_lshlrev_b32 v200, 16, v12
    v_and_b32 v201, 0xffff0000, v12
    v_fmac_f32 v160, v204, v200
    v_fmac_f32 v161, v204, v201

    v_lshlrev_b32 v202, 16, v13
    v_and_b32 v203, 0xffff0000, v13
    v_fmac_f32 v162, v204, v202
    v_fmac_f32 v163, v204, v203

    v_lshlrev_b32 v200, 16, v14
    v_and_b32 v201, 0xffff0000, v14
    v_fmac_f32 v164, v204, v200
    v_fmac_f32 v165, v204, v201

    v_lshlrev_b32 v202, 16, v15
    v_and_b32 v203, 0xffff0000, v15
    v_fmac_f32 v166, v204, v202
    v_fmac_f32 v167, v204, v203

L_fc_r1_u1:
    v_sub_f32 v204, v96, v196
    v_exp_f32 v204, v204
    s_nop 0
    v_fmac_f32 v194, v204, v97
    s_waitcnt vmcnt(0)
    v_lshlrev_b32 v200, 16, v0
    v_and_b32 v201, 0xffff0000, v0
    v_fmac_f32 v160, v204, v200
    v_fmac_f32 v161, v204, v201

    v_lshlrev_b32 v202, 16, v1
    v_and_b32 v203, 0xffff0000, v1
    v_fmac_f32 v162, v204, v202
    v_fmac_f32 v163, v204, v203

    v_lshlrev_b32 v200, 16, v2
    v_and_b32 v201, 0xffff0000, v2
    v_fmac_f32 v164, v204, v200
    v_fmac_f32 v165, v204, v201

    v_lshlrev_b32 v202, 16, v3
    v_and_b32 v203, 0xffff0000, v3
    v_fmac_f32 v166, v204, v202
    v_fmac_f32 v167, v204, v203

L_fc_r1_u0:
    s_cmp_lg_u64 s[62:63], s[56:57]
    s_cbranch_scc1 L_fc_poll

    s_branch L_fc_store
L_fc_r2:
    s_cmp_le_u32 s68, 7
    s_cbranch_scc1 L_fc_r2_p7

    buffer_load_dwordx4 v[84:87], v206, s[36:39], s45 offen offset:0 sc1
    buffer_load_dwordx4 v[88:91], v206, s[36:39], s45 offen offset:1024 sc1
L_fc_r2_p7:
    s_cmp_le_u32 s68, 6
    s_cbranch_scc1 L_fc_r2_p6

    buffer_load_dwordx4 v[72:75], v206, s[36:39], s44 offen offset:0 sc1
    buffer_load_dwordx4 v[76:79], v206, s[36:39], s44 offen offset:1024 sc1
L_fc_r2_p6:
    s_cmp_le_u32 s68, 5
    s_cbranch_scc1 L_fc_r2_p5

    buffer_load_dwordx4 v[60:63], v206, s[36:39], s73 offen offset:0 sc1
    buffer_load_dwordx4 v[64:67], v206, s[36:39], s73 offen offset:1024 sc1
L_fc_r2_p5:
    s_cmp_le_u32 s68, 4
    s_cbranch_scc1 L_fc_r2_p4

    s_cmp_gt_u32 s68, 7
    s_cbranch_scc1 L_fc_r2_pd

    buffer_load_dwordx4 v[48:51], v206, s[36:39], s71 offen offset:0 sc1
    buffer_load_dwordx4 v[52:55], v206, s[36:39], s71 offen offset:1024 sc1
L_fc_r2_p4:
    s_cmp_le_u32 s68, 3
    s_cbranch_scc1 L_fc_r2_p3

    s_cmp_gt_u32 s68, 6
    s_cbranch_scc1 L_fc_r2_pd

    buffer_load_dwordx4 v[36:39], v206, s[36:39], s51 offen offset:0 sc1
    buffer_load_dwordx4 v[40:43], v206, s[36:39], s51 offen offset:1024 sc1
L_fc_r2_p3:
    s_cmp_le_u32 s68, 2
    s_cbranch_scc1 L_fc_r2_p2

    s_cmp_gt_u32 s68, 5
    s_cbranch_scc1 L_fc_r2_pd

    buffer_load_dwordx4 v[24:27], v206, s[36:39], s50 offen offset:0 sc1
    buffer_load_dwordx4 v[28:31], v206, s[36:39], s50 offen offset:1024 sc1
L_fc_r2_p2:
    s_cmp_le_u32 s68, 1
    s_cbranch_scc1 L_fc_r2_p1

    s_cmp_gt_u32 s68, 4
    s_cbranch_scc1 L_fc_r2_pd

    buffer_load_dwordx4 v[12:15], v206, s[36:39], s49 offen offset:0 sc1
    buffer_load_dwordx4 v[16:19], v206, s[36:39], s49 offen offset:1024 sc1
L_fc_r2_p1:
    s_cmp_le_u32 s68, 0
    s_cbranch_scc1 L_fc_r2_p0

    s_cmp_gt_u32 s68, 3
    s_cbranch_scc1 L_fc_r2_pd

    buffer_load_dwordx4 v[0:3], v206, s[36:39], s48 offen offset:0 sc1
    buffer_load_dwordx4 v[4:7], v206, s[36:39], s48 offen offset:1024 sc1
L_fc_r2_p0:
L_fc_r2_pd:
    s_cmp_eq_u32 s68, 1
    s_cbranch_scc0 L_fc_r2_w1
    s_waitcnt vmcnt(2)

L_fc_r2_w1:
    s_cmp_eq_u32 s68, 2
    s_cbranch_scc0 L_fc_r2_w2
    s_waitcnt vmcnt(4)

L_fc_r2_w2:
    s_waitcnt vmcnt(6)
    v_max_f32 v196, v196, v96
    v_max_f32 v197, v197, v98
    s_cmp_le_u32 s68, 1
    s_cbranch_scc1 L_fc_r2_max

    v_max_f32 v196, v196, v100
    v_max_f32 v197, v197, v102
    s_cmp_le_u32 s68, 2
    s_cbranch_scc1 L_fc_r2_max

    v_max_f32 v196, v196, v104
    v_max_f32 v197, v197, v106
    s_cmp_le_u32 s68, 3
    s_cbranch_scc1 L_fc_r2_max

    v_max_f32 v196, v196, v108
    v_max_f32 v197, v197, v110
    s_cmp_le_u32 s68, 4
    s_cbranch_scc1 L_fc_r2_max

    v_max_f32 v196, v196, v112
    v_max_f32 v197, v197, v114
    s_cmp_le_u32 s68, 5
    s_cbranch_scc1 L_fc_r2_max

    v_max_f32 v196, v196, v116
    v_max_f32 v197, v197, v118
    s_cmp_le_u32 s68, 6
    s_cbranch_scc1 L_fc_r2_max

    v_max_f32 v196, v196, v120
    v_max_f32 v197, v197, v122
    s_cmp_le_u32 s68, 7
    s_cbranch_scc1 L_fc_r2_max

    v_max_f32 v196, v196, v124
    v_max_f32 v197, v197, v126
L_fc_r2_max:
    v_sub_f32 v198, v192, v196
    v_exp_f32 v198, v198
    v_mov_b32 v192, v196

    v_sub_f32 v199, v193, v197
    v_exp_f32 v199, v199
    v_mov_b32 v193, v197

    v_mul_f32 v194, v194, v198
    v_mul_f32 v195, v195, v199
    v_mul_f32 v160, v160, v198
    v_mul_f32 v161, v161, v198
    v_mul_f32 v162, v162, v198
    v_mul_f32 v163, v163, v198
    v_mul_f32 v164, v164, v198
    v_mul_f32 v165, v165, v198
    v_mul_f32 v166, v166, v198
    v_mul_f32 v167, v167, v198
    v_cndmask_b32 v211, v198, v199, s[66:67]
    v_mul_f32 v168, v168, v211
    v_mul_f32 v169, v169, v211
    v_mul_f32 v170, v170, v211
    v_mul_f32 v171, v171, v211
    v_mul_f32 v172, v172, v211
    v_mul_f32 v173, v173, v211
    v_mul_f32 v174, v174, v211
    v_mul_f32 v175, v175, v211
    s_cmp_le_u32 s68, 7
    s_cbranch_scc1 L_fc_r2_u7

    buffer_load_dwordx4 v[48:51], v206, s[36:39], s71 offen offset:0 sc1
    buffer_load_dwordx4 v[52:55], v206, s[36:39], s71 offen offset:1024 sc1
    v_sub_f32 v204, v124, v196
    v_sub_f32 v205, v126, v197
    v_exp_f32 v204, v204
    v_exp_f32 v205, v205
    s_nop 0
    v_fmac_f32 v194, v204, v125
    v_fmac_f32 v195, v205, v127
    s_waitcnt vmcnt(7)
    v_lshlrev_b32 v200, 16, v84
    v_and_b32 v201, 0xffff0000, v84
    v_fmac_f32 v160, v204, v200
    v_fmac_f32 v161, v204, v201

    v_lshlrev_b32 v202, 16, v85
    v_and_b32 v203, 0xffff0000, v85
    v_fmac_f32 v162, v204, v202
    v_fmac_f32 v163, v204, v203

    v_lshlrev_b32 v200, 16, v86
    v_and_b32 v201, 0xffff0000, v86
    v_fmac_f32 v164, v204, v200
    v_fmac_f32 v165, v204, v201

    v_lshlrev_b32 v202, 16, v87
    v_and_b32 v203, 0xffff0000, v87
    v_fmac_f32 v166, v204, v202
    v_fmac_f32 v167, v204, v203

    v_cndmask_b32 v211, v204, v205, s[66:67]
    s_waitcnt vmcnt(6)
    v_lshlrev_b32 v200, 16, v88
    v_and_b32 v201, 0xffff0000, v88
    v_fmac_f32 v168, v211, v200
    v_fmac_f32 v169, v211, v201

    v_lshlrev_b32 v202, 16, v89
    v_and_b32 v203, 0xffff0000, v89
    v_fmac_f32 v170, v211, v202
    v_fmac_f32 v171, v211, v203

    v_lshlrev_b32 v200, 16, v90
    v_and_b32 v201, 0xffff0000, v90
    v_fmac_f32 v172, v211, v200
    v_fmac_f32 v173, v211, v201

    v_lshlrev_b32 v202, 16, v91
    v_and_b32 v203, 0xffff0000, v91
    v_fmac_f32 v174, v211, v202
    v_fmac_f32 v175, v211, v203

L_fc_r2_u7:
    s_cmp_le_u32 s68, 6
    s_cbranch_scc1 L_fc_r2_u6

    buffer_load_dwordx4 v[36:39], v206, s[36:39], s51 offen offset:0 sc1
    buffer_load_dwordx4 v[40:43], v206, s[36:39], s51 offen offset:1024 sc1
    v_sub_f32 v204, v120, v196
    v_sub_f32 v205, v122, v197
    v_exp_f32 v204, v204
    v_exp_f32 v205, v205
    s_nop 0
    v_fmac_f32 v194, v204, v121
    v_fmac_f32 v195, v205, v123
    s_waitcnt vmcnt(7)
    v_lshlrev_b32 v200, 16, v72
    v_and_b32 v201, 0xffff0000, v72
    v_fmac_f32 v160, v204, v200
    v_fmac_f32 v161, v204, v201

    v_lshlrev_b32 v202, 16, v73
    v_and_b32 v203, 0xffff0000, v73
    v_fmac_f32 v162, v204, v202
    v_fmac_f32 v163, v204, v203

    v_lshlrev_b32 v200, 16, v74
    v_and_b32 v201, 0xffff0000, v74
    v_fmac_f32 v164, v204, v200
    v_fmac_f32 v165, v204, v201

    v_lshlrev_b32 v202, 16, v75
    v_and_b32 v203, 0xffff0000, v75
    v_fmac_f32 v166, v204, v202
    v_fmac_f32 v167, v204, v203

    v_cndmask_b32 v211, v204, v205, s[66:67]
    s_waitcnt vmcnt(6)
    v_lshlrev_b32 v200, 16, v76
    v_and_b32 v201, 0xffff0000, v76
    v_fmac_f32 v168, v211, v200
    v_fmac_f32 v169, v211, v201

    v_lshlrev_b32 v202, 16, v77
    v_and_b32 v203, 0xffff0000, v77
    v_fmac_f32 v170, v211, v202
    v_fmac_f32 v171, v211, v203

    v_lshlrev_b32 v200, 16, v78
    v_and_b32 v201, 0xffff0000, v78
    v_fmac_f32 v172, v211, v200
    v_fmac_f32 v173, v211, v201

    v_lshlrev_b32 v202, 16, v79
    v_and_b32 v203, 0xffff0000, v79
    v_fmac_f32 v174, v211, v202
    v_fmac_f32 v175, v211, v203

L_fc_r2_u6:
    s_cmp_le_u32 s68, 5
    s_cbranch_scc1 L_fc_r2_u5

    buffer_load_dwordx4 v[24:27], v206, s[36:39], s50 offen offset:0 sc1
    buffer_load_dwordx4 v[28:31], v206, s[36:39], s50 offen offset:1024 sc1
    v_sub_f32 v204, v116, v196
    v_sub_f32 v205, v118, v197
    v_exp_f32 v204, v204
    v_exp_f32 v205, v205
    s_nop 0
    v_fmac_f32 v194, v204, v117
    v_fmac_f32 v195, v205, v119
    s_waitcnt vmcnt(7)
    v_lshlrev_b32 v200, 16, v60
    v_and_b32 v201, 0xffff0000, v60
    v_fmac_f32 v160, v204, v200
    v_fmac_f32 v161, v204, v201

    v_lshlrev_b32 v202, 16, v61
    v_and_b32 v203, 0xffff0000, v61
    v_fmac_f32 v162, v204, v202
    v_fmac_f32 v163, v204, v203

    v_lshlrev_b32 v200, 16, v62
    v_and_b32 v201, 0xffff0000, v62
    v_fmac_f32 v164, v204, v200
    v_fmac_f32 v165, v204, v201

    v_lshlrev_b32 v202, 16, v63
    v_and_b32 v203, 0xffff0000, v63
    v_fmac_f32 v166, v204, v202
    v_fmac_f32 v167, v204, v203

    v_cndmask_b32 v211, v204, v205, s[66:67]
    s_waitcnt vmcnt(6)
    v_lshlrev_b32 v200, 16, v64
    v_and_b32 v201, 0xffff0000, v64
    v_fmac_f32 v168, v211, v200
    v_fmac_f32 v169, v211, v201

    v_lshlrev_b32 v202, 16, v65
    v_and_b32 v203, 0xffff0000, v65
    v_fmac_f32 v170, v211, v202
    v_fmac_f32 v171, v211, v203

    v_lshlrev_b32 v200, 16, v66
    v_and_b32 v201, 0xffff0000, v66
    v_fmac_f32 v172, v211, v200
    v_fmac_f32 v173, v211, v201

    v_lshlrev_b32 v202, 16, v67
    v_and_b32 v203, 0xffff0000, v67
    v_fmac_f32 v174, v211, v202
    v_fmac_f32 v175, v211, v203

L_fc_r2_u5:
    s_cmp_le_u32 s68, 4
    s_cbranch_scc1 L_fc_r2_u4

    buffer_load_dwordx4 v[12:15], v206, s[36:39], s49 offen offset:0 sc1
    buffer_load_dwordx4 v[16:19], v206, s[36:39], s49 offen offset:1024 sc1
    v_sub_f32 v204, v112, v196
    v_sub_f32 v205, v114, v197
    v_exp_f32 v204, v204
    v_exp_f32 v205, v205
    s_nop 0
    v_fmac_f32 v194, v204, v113
    v_fmac_f32 v195, v205, v115
    s_waitcnt vmcnt(7)
    v_lshlrev_b32 v200, 16, v48
    v_and_b32 v201, 0xffff0000, v48
    v_fmac_f32 v160, v204, v200
    v_fmac_f32 v161, v204, v201

    v_lshlrev_b32 v202, 16, v49
    v_and_b32 v203, 0xffff0000, v49
    v_fmac_f32 v162, v204, v202
    v_fmac_f32 v163, v204, v203

    v_lshlrev_b32 v200, 16, v50
    v_and_b32 v201, 0xffff0000, v50
    v_fmac_f32 v164, v204, v200
    v_fmac_f32 v165, v204, v201

    v_lshlrev_b32 v202, 16, v51
    v_and_b32 v203, 0xffff0000, v51
    v_fmac_f32 v166, v204, v202
    v_fmac_f32 v167, v204, v203

    v_cndmask_b32 v211, v204, v205, s[66:67]
    s_waitcnt vmcnt(6)
    v_lshlrev_b32 v200, 16, v52
    v_and_b32 v201, 0xffff0000, v52
    v_fmac_f32 v168, v211, v200
    v_fmac_f32 v169, v211, v201

    v_lshlrev_b32 v202, 16, v53
    v_and_b32 v203, 0xffff0000, v53
    v_fmac_f32 v170, v211, v202
    v_fmac_f32 v171, v211, v203

    v_lshlrev_b32 v200, 16, v54
    v_and_b32 v201, 0xffff0000, v54
    v_fmac_f32 v172, v211, v200
    v_fmac_f32 v173, v211, v201

    v_lshlrev_b32 v202, 16, v55
    v_and_b32 v203, 0xffff0000, v55
    v_fmac_f32 v174, v211, v202
    v_fmac_f32 v175, v211, v203

L_fc_r2_u4:
    s_cmp_le_u32 s68, 3
    s_cbranch_scc1 L_fc_r2_u3

    buffer_load_dwordx4 v[0:3], v206, s[36:39], s48 offen offset:0 sc1
    buffer_load_dwordx4 v[4:7], v206, s[36:39], s48 offen offset:1024 sc1
    v_sub_f32 v204, v108, v196
    v_sub_f32 v205, v110, v197
    v_exp_f32 v204, v204
    v_exp_f32 v205, v205
    s_nop 0
    v_fmac_f32 v194, v204, v109
    v_fmac_f32 v195, v205, v111
    s_waitcnt vmcnt(7)
    v_lshlrev_b32 v200, 16, v36
    v_and_b32 v201, 0xffff0000, v36
    v_fmac_f32 v160, v204, v200
    v_fmac_f32 v161, v204, v201

    v_lshlrev_b32 v202, 16, v37
    v_and_b32 v203, 0xffff0000, v37
    v_fmac_f32 v162, v204, v202
    v_fmac_f32 v163, v204, v203

    v_lshlrev_b32 v200, 16, v38
    v_and_b32 v201, 0xffff0000, v38
    v_fmac_f32 v164, v204, v200
    v_fmac_f32 v165, v204, v201

    v_lshlrev_b32 v202, 16, v39
    v_and_b32 v203, 0xffff0000, v39
    v_fmac_f32 v166, v204, v202
    v_fmac_f32 v167, v204, v203

    v_cndmask_b32 v211, v204, v205, s[66:67]
    s_waitcnt vmcnt(6)
    v_lshlrev_b32 v200, 16, v40
    v_and_b32 v201, 0xffff0000, v40
    v_fmac_f32 v168, v211, v200
    v_fmac_f32 v169, v211, v201

    v_lshlrev_b32 v202, 16, v41
    v_and_b32 v203, 0xffff0000, v41
    v_fmac_f32 v170, v211, v202
    v_fmac_f32 v171, v211, v203

    v_lshlrev_b32 v200, 16, v42
    v_and_b32 v201, 0xffff0000, v42
    v_fmac_f32 v172, v211, v200
    v_fmac_f32 v173, v211, v201

    v_lshlrev_b32 v202, 16, v43
    v_and_b32 v203, 0xffff0000, v43
    v_fmac_f32 v174, v211, v202
    v_fmac_f32 v175, v211, v203

L_fc_r2_u3:
    s_cmp_le_u32 s68, 2
    s_cbranch_scc1 L_fc_r2_u2

    v_sub_f32 v204, v104, v196
    v_sub_f32 v205, v106, v197
    v_exp_f32 v204, v204
    v_exp_f32 v205, v205
    s_nop 0
    v_fmac_f32 v194, v204, v105
    v_fmac_f32 v195, v205, v107
    s_waitcnt vmcnt(5)
    v_lshlrev_b32 v200, 16, v24
    v_and_b32 v201, 0xffff0000, v24
    v_fmac_f32 v160, v204, v200
    v_fmac_f32 v161, v204, v201

    v_lshlrev_b32 v202, 16, v25
    v_and_b32 v203, 0xffff0000, v25
    v_fmac_f32 v162, v204, v202
    v_fmac_f32 v163, v204, v203

    v_lshlrev_b32 v200, 16, v26
    v_and_b32 v201, 0xffff0000, v26
    v_fmac_f32 v164, v204, v200
    v_fmac_f32 v165, v204, v201

    v_lshlrev_b32 v202, 16, v27
    v_and_b32 v203, 0xffff0000, v27
    v_fmac_f32 v166, v204, v202
    v_fmac_f32 v167, v204, v203

    v_cndmask_b32 v211, v204, v205, s[66:67]
    s_waitcnt vmcnt(4)
    v_lshlrev_b32 v200, 16, v28
    v_and_b32 v201, 0xffff0000, v28
    v_fmac_f32 v168, v211, v200
    v_fmac_f32 v169, v211, v201

    v_lshlrev_b32 v202, 16, v29
    v_and_b32 v203, 0xffff0000, v29
    v_fmac_f32 v170, v211, v202
    v_fmac_f32 v171, v211, v203

    v_lshlrev_b32 v200, 16, v30
    v_and_b32 v201, 0xffff0000, v30
    v_fmac_f32 v172, v211, v200
    v_fmac_f32 v173, v211, v201

    v_lshlrev_b32 v202, 16, v31
    v_and_b32 v203, 0xffff0000, v31
    v_fmac_f32 v174, v211, v202
    v_fmac_f32 v175, v211, v203

L_fc_r2_u2:
    s_cmp_le_u32 s68, 1
    s_cbranch_scc1 L_fc_r2_u1

    v_sub_f32 v204, v100, v196
    v_sub_f32 v205, v102, v197
    v_exp_f32 v204, v204
    v_exp_f32 v205, v205
    s_nop 0
    v_fmac_f32 v194, v204, v101
    v_fmac_f32 v195, v205, v103
    s_waitcnt vmcnt(3)
    v_lshlrev_b32 v200, 16, v12
    v_and_b32 v201, 0xffff0000, v12
    v_fmac_f32 v160, v204, v200
    v_fmac_f32 v161, v204, v201

    v_lshlrev_b32 v202, 16, v13
    v_and_b32 v203, 0xffff0000, v13
    v_fmac_f32 v162, v204, v202
    v_fmac_f32 v163, v204, v203

    v_lshlrev_b32 v200, 16, v14
    v_and_b32 v201, 0xffff0000, v14
    v_fmac_f32 v164, v204, v200
    v_fmac_f32 v165, v204, v201

    v_lshlrev_b32 v202, 16, v15
    v_and_b32 v203, 0xffff0000, v15
    v_fmac_f32 v166, v204, v202
    v_fmac_f32 v167, v204, v203

    v_cndmask_b32 v211, v204, v205, s[66:67]
    s_waitcnt vmcnt(2)
    v_lshlrev_b32 v200, 16, v16
    v_and_b32 v201, 0xffff0000, v16
    v_fmac_f32 v168, v211, v200
    v_fmac_f32 v169, v211, v201

    v_lshlrev_b32 v202, 16, v17
    v_and_b32 v203, 0xffff0000, v17
    v_fmac_f32 v170, v211, v202
    v_fmac_f32 v171, v211, v203

    v_lshlrev_b32 v200, 16, v18
    v_and_b32 v201, 0xffff0000, v18
    v_fmac_f32 v172, v211, v200
    v_fmac_f32 v173, v211, v201

    v_lshlrev_b32 v202, 16, v19
    v_and_b32 v203, 0xffff0000, v19
    v_fmac_f32 v174, v211, v202
    v_fmac_f32 v175, v211, v203

L_fc_r2_u1:
    v_sub_f32 v204, v96, v196
    v_sub_f32 v205, v98, v197
    v_exp_f32 v204, v204
    v_exp_f32 v205, v205
    s_nop 0
    v_fmac_f32 v194, v204, v97
    v_fmac_f32 v195, v205, v99
    s_waitcnt vmcnt(1)
    v_lshlrev_b32 v200, 16, v0
    v_and_b32 v201, 0xffff0000, v0
    v_fmac_f32 v160, v204, v200
    v_fmac_f32 v161, v204, v201

    v_lshlrev_b32 v202, 16, v1
    v_and_b32 v203, 0xffff0000, v1
    v_fmac_f32 v162, v204, v202
    v_fmac_f32 v163, v204, v203

    v_lshlrev_b32 v200, 16, v2
    v_and_b32 v201, 0xffff0000, v2
    v_fmac_f32 v164, v204, v200
    v_fmac_f32 v165, v204, v201

    v_lshlrev_b32 v202, 16, v3
    v_and_b32 v203, 0xffff0000, v3
    v_fmac_f32 v166, v204, v202
    v_fmac_f32 v167, v204, v203

    v_cndmask_b32 v211, v204, v205, s[66:67]
    s_waitcnt vmcnt(0)
    v_lshlrev_b32 v200, 16, v4
    v_and_b32 v201, 0xffff0000, v4
    v_fmac_f32 v168, v211, v200
    v_fmac_f32 v169, v211, v201

    v_lshlrev_b32 v202, 16, v5
    v_and_b32 v203, 0xffff0000, v5
    v_fmac_f32 v170, v211, v202
    v_fmac_f32 v171, v211, v203

    v_lshlrev_b32 v200, 16, v6
    v_and_b32 v201, 0xffff0000, v6
    v_fmac_f32 v172, v211, v200
    v_fmac_f32 v173, v211, v201

    v_lshlrev_b32 v202, 16, v7
    v_and_b32 v203, 0xffff0000, v7
    v_fmac_f32 v174, v211, v202
    v_fmac_f32 v175, v211, v203

L_fc_r2_u0:
    s_cmp_lg_u64 s[62:63], s[56:57]
    s_cbranch_scc1 L_fc_poll

    s_branch L_fc_store
L_fc_r3:
    s_cmp_le_u32 s68, 7
    s_cbranch_scc1 L_fc_r3_p7

    buffer_load_dwordx4 v[84:87], v206, s[36:39], s45 offen offset:0 sc1
    buffer_load_dwordx4 v[88:91], v206, s[36:39], s45 offen offset:1024 sc1
    buffer_load_dwordx4 v[92:95], v206, s[36:39], s45 offen offset:2048 sc1
L_fc_r3_p7:
    s_cmp_le_u32 s68, 6
    s_cbranch_scc1 L_fc_r3_p6

    buffer_load_dwordx4 v[72:75], v206, s[36:39], s44 offen offset:0 sc1
    buffer_load_dwordx4 v[76:79], v206, s[36:39], s44 offen offset:1024 sc1
    buffer_load_dwordx4 v[80:83], v206, s[36:39], s44 offen offset:2048 sc1
L_fc_r3_p6:
    s_cmp_le_u32 s68, 5
    s_cbranch_scc1 L_fc_r3_p5

    buffer_load_dwordx4 v[60:63], v206, s[36:39], s73 offen offset:0 sc1
    buffer_load_dwordx4 v[64:67], v206, s[36:39], s73 offen offset:1024 sc1
    buffer_load_dwordx4 v[68:71], v206, s[36:39], s73 offen offset:2048 sc1
L_fc_r3_p5:
    s_cmp_le_u32 s68, 4
    s_cbranch_scc1 L_fc_r3_p4

    s_cmp_gt_u32 s68, 7
    s_cbranch_scc1 L_fc_r3_pd

    buffer_load_dwordx4 v[48:51], v206, s[36:39], s71 offen offset:0 sc1
    buffer_load_dwordx4 v[52:55], v206, s[36:39], s71 offen offset:1024 sc1
    buffer_load_dwordx4 v[56:59], v206, s[36:39], s71 offen offset:2048 sc1
L_fc_r3_p4:
    s_cmp_le_u32 s68, 3
    s_cbranch_scc1 L_fc_r3_p3

    s_cmp_gt_u32 s68, 6
    s_cbranch_scc1 L_fc_r3_pd

    buffer_load_dwordx4 v[36:39], v206, s[36:39], s51 offen offset:0 sc1
    buffer_load_dwordx4 v[40:43], v206, s[36:39], s51 offen offset:1024 sc1
    buffer_load_dwordx4 v[44:47], v206, s[36:39], s51 offen offset:2048 sc1
L_fc_r3_p3:
    s_cmp_le_u32 s68, 2
    s_cbranch_scc1 L_fc_r3_p2

    s_cmp_gt_u32 s68, 5
    s_cbranch_scc1 L_fc_r3_pd

    buffer_load_dwordx4 v[24:27], v206, s[36:39], s50 offen offset:0 sc1
    buffer_load_dwordx4 v[28:31], v206, s[36:39], s50 offen offset:1024 sc1
    buffer_load_dwordx4 v[32:35], v206, s[36:39], s50 offen offset:2048 sc1
L_fc_r3_p2:
    s_cmp_le_u32 s68, 1
    s_cbranch_scc1 L_fc_r3_p1

    s_cmp_gt_u32 s68, 4
    s_cbranch_scc1 L_fc_r3_pd

    buffer_load_dwordx4 v[12:15], v206, s[36:39], s49 offen offset:0 sc1
    buffer_load_dwordx4 v[16:19], v206, s[36:39], s49 offen offset:1024 sc1
    buffer_load_dwordx4 v[20:23], v206, s[36:39], s49 offen offset:2048 sc1
L_fc_r3_p1:
    s_cmp_le_u32 s68, 0
    s_cbranch_scc1 L_fc_r3_p0

    s_cmp_gt_u32 s68, 3
    s_cbranch_scc1 L_fc_r3_pd

    buffer_load_dwordx4 v[0:3], v206, s[36:39], s48 offen offset:0 sc1
    buffer_load_dwordx4 v[4:7], v206, s[36:39], s48 offen offset:1024 sc1
    buffer_load_dwordx4 v[8:11], v206, s[36:39], s48 offen offset:2048 sc1
L_fc_r3_p0:
L_fc_r3_pd:
    s_cmp_eq_u32 s68, 1
    s_cbranch_scc0 L_fc_r3_w1
    s_waitcnt vmcnt(3)

L_fc_r3_w1:
    s_cmp_eq_u32 s68, 2
    s_cbranch_scc0 L_fc_r3_w2
    s_waitcnt vmcnt(6)

L_fc_r3_w2:
    s_waitcnt vmcnt(9)
    v_max_f32 v196, v196, v96
    v_max_f32 v197, v197, v98
    s_cmp_le_u32 s68, 1
    s_cbranch_scc1 L_fc_r3_max

    v_max_f32 v196, v196, v100
    v_max_f32 v197, v197, v102
    s_cmp_le_u32 s68, 2
    s_cbranch_scc1 L_fc_r3_max

    v_max_f32 v196, v196, v104
    v_max_f32 v197, v197, v106
    s_cmp_le_u32 s68, 3
    s_cbranch_scc1 L_fc_r3_max

    v_max_f32 v196, v196, v108
    v_max_f32 v197, v197, v110
    s_cmp_le_u32 s68, 4
    s_cbranch_scc1 L_fc_r3_max

    v_max_f32 v196, v196, v112
    v_max_f32 v197, v197, v114
    s_cmp_le_u32 s68, 5
    s_cbranch_scc1 L_fc_r3_max

    v_max_f32 v196, v196, v116
    v_max_f32 v197, v197, v118
    s_cmp_le_u32 s68, 6
    s_cbranch_scc1 L_fc_r3_max

    v_max_f32 v196, v196, v120
    v_max_f32 v197, v197, v122
    s_cmp_le_u32 s68, 7
    s_cbranch_scc1 L_fc_r3_max

    v_max_f32 v196, v196, v124
    v_max_f32 v197, v197, v126
L_fc_r3_max:
    v_sub_f32 v198, v192, v196
    v_exp_f32 v198, v198
    v_mov_b32 v192, v196

    v_sub_f32 v199, v193, v197
    v_exp_f32 v199, v199
    v_mov_b32 v193, v197

    v_mul_f32 v194, v194, v198
    v_mul_f32 v195, v195, v199
    v_mul_f32 v160, v160, v198
    v_mul_f32 v161, v161, v198
    v_mul_f32 v162, v162, v198
    v_mul_f32 v163, v163, v198
    v_mul_f32 v164, v164, v198
    v_mul_f32 v165, v165, v198
    v_mul_f32 v166, v166, v198
    v_mul_f32 v167, v167, v198
    v_cndmask_b32 v211, v198, v199, s[66:67]
    v_mul_f32 v168, v168, v211
    v_mul_f32 v169, v169, v211
    v_mul_f32 v170, v170, v211
    v_mul_f32 v171, v171, v211
    v_mul_f32 v172, v172, v211
    v_mul_f32 v173, v173, v211
    v_mul_f32 v174, v174, v211
    v_mul_f32 v175, v175, v211
    v_cndmask_b32 v211, v198, v199, s[76:77]
    v_mul_f32 v176, v176, v211
    v_mul_f32 v177, v177, v211
    v_mul_f32 v178, v178, v211
    v_mul_f32 v179, v179, v211
    v_mul_f32 v180, v180, v211
    v_mul_f32 v181, v181, v211
    v_mul_f32 v182, v182, v211
    v_mul_f32 v183, v183, v211
    s_cmp_le_u32 s68, 7
    s_cbranch_scc1 L_fc_r3_u7

    buffer_load_dwordx4 v[48:51], v206, s[36:39], s71 offen offset:0 sc1
    buffer_load_dwordx4 v[52:55], v206, s[36:39], s71 offen offset:1024 sc1
    buffer_load_dwordx4 v[56:59], v206, s[36:39], s71 offen offset:2048 sc1
    v_sub_f32 v204, v124, v196
    v_sub_f32 v205, v126, v197
    v_exp_f32 v204, v204
    v_exp_f32 v205, v205
    s_nop 0
    v_fmac_f32 v194, v204, v125
    v_fmac_f32 v195, v205, v127
    s_waitcnt vmcnt(11)
    v_lshlrev_b32 v200, 16, v84
    v_and_b32 v201, 0xffff0000, v84
    v_fmac_f32 v160, v204, v200
    v_fmac_f32 v161, v204, v201

    v_lshlrev_b32 v202, 16, v85
    v_and_b32 v203, 0xffff0000, v85
    v_fmac_f32 v162, v204, v202
    v_fmac_f32 v163, v204, v203

    v_lshlrev_b32 v200, 16, v86
    v_and_b32 v201, 0xffff0000, v86
    v_fmac_f32 v164, v204, v200
    v_fmac_f32 v165, v204, v201

    v_lshlrev_b32 v202, 16, v87
    v_and_b32 v203, 0xffff0000, v87
    v_fmac_f32 v166, v204, v202
    v_fmac_f32 v167, v204, v203

    v_cndmask_b32 v211, v204, v205, s[66:67]
    s_waitcnt vmcnt(10)
    v_lshlrev_b32 v200, 16, v88
    v_and_b32 v201, 0xffff0000, v88
    v_fmac_f32 v168, v211, v200
    v_fmac_f32 v169, v211, v201

    v_lshlrev_b32 v202, 16, v89
    v_and_b32 v203, 0xffff0000, v89
    v_fmac_f32 v170, v211, v202
    v_fmac_f32 v171, v211, v203

    v_lshlrev_b32 v200, 16, v90
    v_and_b32 v201, 0xffff0000, v90
    v_fmac_f32 v172, v211, v200
    v_fmac_f32 v173, v211, v201

    v_lshlrev_b32 v202, 16, v91
    v_and_b32 v203, 0xffff0000, v91
    v_fmac_f32 v174, v211, v202
    v_fmac_f32 v175, v211, v203

    v_cndmask_b32 v211, v204, v205, s[76:77]
    s_waitcnt vmcnt(9)
    v_lshlrev_b32 v200, 16, v92
    v_and_b32 v201, 0xffff0000, v92
    v_fmac_f32 v176, v211, v200
    v_fmac_f32 v177, v211, v201

    v_lshlrev_b32 v202, 16, v93
    v_and_b32 v203, 0xffff0000, v93
    v_fmac_f32 v178, v211, v202
    v_fmac_f32 v179, v211, v203

    v_lshlrev_b32 v200, 16, v94
    v_and_b32 v201, 0xffff0000, v94
    v_fmac_f32 v180, v211, v200
    v_fmac_f32 v181, v211, v201

    v_lshlrev_b32 v202, 16, v95
    v_and_b32 v203, 0xffff0000, v95
    v_fmac_f32 v182, v211, v202
    v_fmac_f32 v183, v211, v203

L_fc_r3_u7:
    s_cmp_le_u32 s68, 6
    s_cbranch_scc1 L_fc_r3_u6

    buffer_load_dwordx4 v[36:39], v206, s[36:39], s51 offen offset:0 sc1
    buffer_load_dwordx4 v[40:43], v206, s[36:39], s51 offen offset:1024 sc1
    buffer_load_dwordx4 v[44:47], v206, s[36:39], s51 offen offset:2048 sc1
    v_sub_f32 v204, v120, v196
    v_sub_f32 v205, v122, v197
    v_exp_f32 v204, v204
    v_exp_f32 v205, v205
    s_nop 0
    v_fmac_f32 v194, v204, v121
    v_fmac_f32 v195, v205, v123
    s_waitcnt vmcnt(11)
    v_lshlrev_b32 v200, 16, v72
    v_and_b32 v201, 0xffff0000, v72
    v_fmac_f32 v160, v204, v200
    v_fmac_f32 v161, v204, v201

    v_lshlrev_b32 v202, 16, v73
    v_and_b32 v203, 0xffff0000, v73
    v_fmac_f32 v162, v204, v202
    v_fmac_f32 v163, v204, v203

    v_lshlrev_b32 v200, 16, v74
    v_and_b32 v201, 0xffff0000, v74
    v_fmac_f32 v164, v204, v200
    v_fmac_f32 v165, v204, v201

    v_lshlrev_b32 v202, 16, v75
    v_and_b32 v203, 0xffff0000, v75
    v_fmac_f32 v166, v204, v202
    v_fmac_f32 v167, v204, v203

    v_cndmask_b32 v211, v204, v205, s[66:67]
    s_waitcnt vmcnt(10)
    v_lshlrev_b32 v200, 16, v76
    v_and_b32 v201, 0xffff0000, v76
    v_fmac_f32 v168, v211, v200
    v_fmac_f32 v169, v211, v201

    v_lshlrev_b32 v202, 16, v77
    v_and_b32 v203, 0xffff0000, v77
    v_fmac_f32 v170, v211, v202
    v_fmac_f32 v171, v211, v203

    v_lshlrev_b32 v200, 16, v78
    v_and_b32 v201, 0xffff0000, v78
    v_fmac_f32 v172, v211, v200
    v_fmac_f32 v173, v211, v201

    v_lshlrev_b32 v202, 16, v79
    v_and_b32 v203, 0xffff0000, v79
    v_fmac_f32 v174, v211, v202
    v_fmac_f32 v175, v211, v203

    v_cndmask_b32 v211, v204, v205, s[76:77]
    s_waitcnt vmcnt(9)
    v_lshlrev_b32 v200, 16, v80
    v_and_b32 v201, 0xffff0000, v80
    v_fmac_f32 v176, v211, v200
    v_fmac_f32 v177, v211, v201

    v_lshlrev_b32 v202, 16, v81
    v_and_b32 v203, 0xffff0000, v81
    v_fmac_f32 v178, v211, v202
    v_fmac_f32 v179, v211, v203

    v_lshlrev_b32 v200, 16, v82
    v_and_b32 v201, 0xffff0000, v82
    v_fmac_f32 v180, v211, v200
    v_fmac_f32 v181, v211, v201

    v_lshlrev_b32 v202, 16, v83
    v_and_b32 v203, 0xffff0000, v83
    v_fmac_f32 v182, v211, v202
    v_fmac_f32 v183, v211, v203

L_fc_r3_u6:
    s_cmp_le_u32 s68, 5
    s_cbranch_scc1 L_fc_r3_u5

    buffer_load_dwordx4 v[24:27], v206, s[36:39], s50 offen offset:0 sc1
    buffer_load_dwordx4 v[28:31], v206, s[36:39], s50 offen offset:1024 sc1
    buffer_load_dwordx4 v[32:35], v206, s[36:39], s50 offen offset:2048 sc1
    v_sub_f32 v204, v116, v196
    v_sub_f32 v205, v118, v197
    v_exp_f32 v204, v204
    v_exp_f32 v205, v205
    s_nop 0
    v_fmac_f32 v194, v204, v117
    v_fmac_f32 v195, v205, v119
    s_waitcnt vmcnt(11)
    v_lshlrev_b32 v200, 16, v60
    v_and_b32 v201, 0xffff0000, v60
    v_fmac_f32 v160, v204, v200
    v_fmac_f32 v161, v204, v201

    v_lshlrev_b32 v202, 16, v61
    v_and_b32 v203, 0xffff0000, v61
    v_fmac_f32 v162, v204, v202
    v_fmac_f32 v163, v204, v203

    v_lshlrev_b32 v200, 16, v62
    v_and_b32 v201, 0xffff0000, v62
    v_fmac_f32 v164, v204, v200
    v_fmac_f32 v165, v204, v201

    v_lshlrev_b32 v202, 16, v63
    v_and_b32 v203, 0xffff0000, v63
    v_fmac_f32 v166, v204, v202
    v_fmac_f32 v167, v204, v203

    v_cndmask_b32 v211, v204, v205, s[66:67]
    s_waitcnt vmcnt(10)
    v_lshlrev_b32 v200, 16, v64
    v_and_b32 v201, 0xffff0000, v64
    v_fmac_f32 v168, v211, v200
    v_fmac_f32 v169, v211, v201

    v_lshlrev_b32 v202, 16, v65
    v_and_b32 v203, 0xffff0000, v65
    v_fmac_f32 v170, v211, v202
    v_fmac_f32 v171, v211, v203

    v_lshlrev_b32 v200, 16, v66
    v_and_b32 v201, 0xffff0000, v66
    v_fmac_f32 v172, v211, v200
    v_fmac_f32 v173, v211, v201

    v_lshlrev_b32 v202, 16, v67
    v_and_b32 v203, 0xffff0000, v67
    v_fmac_f32 v174, v211, v202
    v_fmac_f32 v175, v211, v203

    v_cndmask_b32 v211, v204, v205, s[76:77]
    s_waitcnt vmcnt(9)
    v_lshlrev_b32 v200, 16, v68
    v_and_b32 v201, 0xffff0000, v68
    v_fmac_f32 v176, v211, v200
    v_fmac_f32 v177, v211, v201

    v_lshlrev_b32 v202, 16, v69
    v_and_b32 v203, 0xffff0000, v69
    v_fmac_f32 v178, v211, v202
    v_fmac_f32 v179, v211, v203

    v_lshlrev_b32 v200, 16, v70
    v_and_b32 v201, 0xffff0000, v70
    v_fmac_f32 v180, v211, v200
    v_fmac_f32 v181, v211, v201

    v_lshlrev_b32 v202, 16, v71
    v_and_b32 v203, 0xffff0000, v71
    v_fmac_f32 v182, v211, v202
    v_fmac_f32 v183, v211, v203

L_fc_r3_u5:
    s_cmp_le_u32 s68, 4
    s_cbranch_scc1 L_fc_r3_u4

    buffer_load_dwordx4 v[12:15], v206, s[36:39], s49 offen offset:0 sc1
    buffer_load_dwordx4 v[16:19], v206, s[36:39], s49 offen offset:1024 sc1
    buffer_load_dwordx4 v[20:23], v206, s[36:39], s49 offen offset:2048 sc1
    v_sub_f32 v204, v112, v196
    v_sub_f32 v205, v114, v197
    v_exp_f32 v204, v204
    v_exp_f32 v205, v205
    s_nop 0
    v_fmac_f32 v194, v204, v113
    v_fmac_f32 v195, v205, v115
    s_waitcnt vmcnt(11)
    v_lshlrev_b32 v200, 16, v48
    v_and_b32 v201, 0xffff0000, v48
    v_fmac_f32 v160, v204, v200
    v_fmac_f32 v161, v204, v201

    v_lshlrev_b32 v202, 16, v49
    v_and_b32 v203, 0xffff0000, v49
    v_fmac_f32 v162, v204, v202
    v_fmac_f32 v163, v204, v203

    v_lshlrev_b32 v200, 16, v50
    v_and_b32 v201, 0xffff0000, v50
    v_fmac_f32 v164, v204, v200
    v_fmac_f32 v165, v204, v201

    v_lshlrev_b32 v202, 16, v51
    v_and_b32 v203, 0xffff0000, v51
    v_fmac_f32 v166, v204, v202
    v_fmac_f32 v167, v204, v203

    v_cndmask_b32 v211, v204, v205, s[66:67]
    s_waitcnt vmcnt(10)
    v_lshlrev_b32 v200, 16, v52
    v_and_b32 v201, 0xffff0000, v52
    v_fmac_f32 v168, v211, v200
    v_fmac_f32 v169, v211, v201

    v_lshlrev_b32 v202, 16, v53
    v_and_b32 v203, 0xffff0000, v53
    v_fmac_f32 v170, v211, v202
    v_fmac_f32 v171, v211, v203

    v_lshlrev_b32 v200, 16, v54
    v_and_b32 v201, 0xffff0000, v54
    v_fmac_f32 v172, v211, v200
    v_fmac_f32 v173, v211, v201

    v_lshlrev_b32 v202, 16, v55
    v_and_b32 v203, 0xffff0000, v55
    v_fmac_f32 v174, v211, v202
    v_fmac_f32 v175, v211, v203

    v_cndmask_b32 v211, v204, v205, s[76:77]
    s_waitcnt vmcnt(9)
    v_lshlrev_b32 v200, 16, v56
    v_and_b32 v201, 0xffff0000, v56
    v_fmac_f32 v176, v211, v200
    v_fmac_f32 v177, v211, v201

    v_lshlrev_b32 v202, 16, v57
    v_and_b32 v203, 0xffff0000, v57
    v_fmac_f32 v178, v211, v202
    v_fmac_f32 v179, v211, v203

    v_lshlrev_b32 v200, 16, v58
    v_and_b32 v201, 0xffff0000, v58
    v_fmac_f32 v180, v211, v200
    v_fmac_f32 v181, v211, v201

    v_lshlrev_b32 v202, 16, v59
    v_and_b32 v203, 0xffff0000, v59
    v_fmac_f32 v182, v211, v202
    v_fmac_f32 v183, v211, v203

L_fc_r3_u4:
    s_cmp_le_u32 s68, 3
    s_cbranch_scc1 L_fc_r3_u3

    buffer_load_dwordx4 v[0:3], v206, s[36:39], s48 offen offset:0 sc1
    buffer_load_dwordx4 v[4:7], v206, s[36:39], s48 offen offset:1024 sc1
    buffer_load_dwordx4 v[8:11], v206, s[36:39], s48 offen offset:2048 sc1
    v_sub_f32 v204, v108, v196
    v_sub_f32 v205, v110, v197
    v_exp_f32 v204, v204
    v_exp_f32 v205, v205
    s_nop 0
    v_fmac_f32 v194, v204, v109
    v_fmac_f32 v195, v205, v111
    s_waitcnt vmcnt(11)
    v_lshlrev_b32 v200, 16, v36
    v_and_b32 v201, 0xffff0000, v36
    v_fmac_f32 v160, v204, v200
    v_fmac_f32 v161, v204, v201

    v_lshlrev_b32 v202, 16, v37
    v_and_b32 v203, 0xffff0000, v37
    v_fmac_f32 v162, v204, v202
    v_fmac_f32 v163, v204, v203

    v_lshlrev_b32 v200, 16, v38
    v_and_b32 v201, 0xffff0000, v38
    v_fmac_f32 v164, v204, v200
    v_fmac_f32 v165, v204, v201

    v_lshlrev_b32 v202, 16, v39
    v_and_b32 v203, 0xffff0000, v39
    v_fmac_f32 v166, v204, v202
    v_fmac_f32 v167, v204, v203

    v_cndmask_b32 v211, v204, v205, s[66:67]
    s_waitcnt vmcnt(10)
    v_lshlrev_b32 v200, 16, v40
    v_and_b32 v201, 0xffff0000, v40
    v_fmac_f32 v168, v211, v200
    v_fmac_f32 v169, v211, v201

    v_lshlrev_b32 v202, 16, v41
    v_and_b32 v203, 0xffff0000, v41
    v_fmac_f32 v170, v211, v202
    v_fmac_f32 v171, v211, v203

    v_lshlrev_b32 v200, 16, v42
    v_and_b32 v201, 0xffff0000, v42
    v_fmac_f32 v172, v211, v200
    v_fmac_f32 v173, v211, v201

    v_lshlrev_b32 v202, 16, v43
    v_and_b32 v203, 0xffff0000, v43
    v_fmac_f32 v174, v211, v202
    v_fmac_f32 v175, v211, v203

    v_cndmask_b32 v211, v204, v205, s[76:77]
    s_waitcnt vmcnt(9)
    v_lshlrev_b32 v200, 16, v44
    v_and_b32 v201, 0xffff0000, v44
    v_fmac_f32 v176, v211, v200
    v_fmac_f32 v177, v211, v201

    v_lshlrev_b32 v202, 16, v45
    v_and_b32 v203, 0xffff0000, v45
    v_fmac_f32 v178, v211, v202
    v_fmac_f32 v179, v211, v203

    v_lshlrev_b32 v200, 16, v46
    v_and_b32 v201, 0xffff0000, v46
    v_fmac_f32 v180, v211, v200
    v_fmac_f32 v181, v211, v201

    v_lshlrev_b32 v202, 16, v47
    v_and_b32 v203, 0xffff0000, v47
    v_fmac_f32 v182, v211, v202
    v_fmac_f32 v183, v211, v203

L_fc_r3_u3:
    s_cmp_le_u32 s68, 2
    s_cbranch_scc1 L_fc_r3_u2

    v_sub_f32 v204, v104, v196
    v_sub_f32 v205, v106, v197
    v_exp_f32 v204, v204
    v_exp_f32 v205, v205
    s_nop 0
    v_fmac_f32 v194, v204, v105
    v_fmac_f32 v195, v205, v107
    s_waitcnt vmcnt(8)
    v_lshlrev_b32 v200, 16, v24
    v_and_b32 v201, 0xffff0000, v24
    v_fmac_f32 v160, v204, v200
    v_fmac_f32 v161, v204, v201

    v_lshlrev_b32 v202, 16, v25
    v_and_b32 v203, 0xffff0000, v25
    v_fmac_f32 v162, v204, v202
    v_fmac_f32 v163, v204, v203

    v_lshlrev_b32 v200, 16, v26
    v_and_b32 v201, 0xffff0000, v26
    v_fmac_f32 v164, v204, v200
    v_fmac_f32 v165, v204, v201

    v_lshlrev_b32 v202, 16, v27
    v_and_b32 v203, 0xffff0000, v27
    v_fmac_f32 v166, v204, v202
    v_fmac_f32 v167, v204, v203

    v_cndmask_b32 v211, v204, v205, s[66:67]
    s_waitcnt vmcnt(7)
    v_lshlrev_b32 v200, 16, v28
    v_and_b32 v201, 0xffff0000, v28
    v_fmac_f32 v168, v211, v200
    v_fmac_f32 v169, v211, v201

    v_lshlrev_b32 v202, 16, v29
    v_and_b32 v203, 0xffff0000, v29
    v_fmac_f32 v170, v211, v202
    v_fmac_f32 v171, v211, v203

    v_lshlrev_b32 v200, 16, v30
    v_and_b32 v201, 0xffff0000, v30
    v_fmac_f32 v172, v211, v200
    v_fmac_f32 v173, v211, v201

    v_lshlrev_b32 v202, 16, v31
    v_and_b32 v203, 0xffff0000, v31
    v_fmac_f32 v174, v211, v202
    v_fmac_f32 v175, v211, v203

    v_cndmask_b32 v211, v204, v205, s[76:77]
    s_waitcnt vmcnt(6)
    v_lshlrev_b32 v200, 16, v32
    v_and_b32 v201, 0xffff0000, v32
    v_fmac_f32 v176, v211, v200
    v_fmac_f32 v177, v211, v201

    v_lshlrev_b32 v202, 16, v33
    v_and_b32 v203, 0xffff0000, v33
    v_fmac_f32 v178, v211, v202
    v_fmac_f32 v179, v211, v203

    v_lshlrev_b32 v200, 16, v34
    v_and_b32 v201, 0xffff0000, v34
    v_fmac_f32 v180, v211, v200
    v_fmac_f32 v181, v211, v201

    v_lshlrev_b32 v202, 16, v35
    v_and_b32 v203, 0xffff0000, v35
    v_fmac_f32 v182, v211, v202
    v_fmac_f32 v183, v211, v203

L_fc_r3_u2:
    s_cmp_le_u32 s68, 1
    s_cbranch_scc1 L_fc_r3_u1

    v_sub_f32 v204, v100, v196
    v_sub_f32 v205, v102, v197
    v_exp_f32 v204, v204
    v_exp_f32 v205, v205
    s_nop 0
    v_fmac_f32 v194, v204, v101
    v_fmac_f32 v195, v205, v103
    s_waitcnt vmcnt(5)
    v_lshlrev_b32 v200, 16, v12
    v_and_b32 v201, 0xffff0000, v12
    v_fmac_f32 v160, v204, v200
    v_fmac_f32 v161, v204, v201

    v_lshlrev_b32 v202, 16, v13
    v_and_b32 v203, 0xffff0000, v13
    v_fmac_f32 v162, v204, v202
    v_fmac_f32 v163, v204, v203

    v_lshlrev_b32 v200, 16, v14
    v_and_b32 v201, 0xffff0000, v14
    v_fmac_f32 v164, v204, v200
    v_fmac_f32 v165, v204, v201

    v_lshlrev_b32 v202, 16, v15
    v_and_b32 v203, 0xffff0000, v15
    v_fmac_f32 v166, v204, v202
    v_fmac_f32 v167, v204, v203

    v_cndmask_b32 v211, v204, v205, s[66:67]
    s_waitcnt vmcnt(4)
    v_lshlrev_b32 v200, 16, v16
    v_and_b32 v201, 0xffff0000, v16
    v_fmac_f32 v168, v211, v200
    v_fmac_f32 v169, v211, v201

    v_lshlrev_b32 v202, 16, v17
    v_and_b32 v203, 0xffff0000, v17
    v_fmac_f32 v170, v211, v202
    v_fmac_f32 v171, v211, v203

    v_lshlrev_b32 v200, 16, v18
    v_and_b32 v201, 0xffff0000, v18
    v_fmac_f32 v172, v211, v200
    v_fmac_f32 v173, v211, v201

    v_lshlrev_b32 v202, 16, v19
    v_and_b32 v203, 0xffff0000, v19
    v_fmac_f32 v174, v211, v202
    v_fmac_f32 v175, v211, v203

    v_cndmask_b32 v211, v204, v205, s[76:77]
    s_waitcnt vmcnt(3)
    v_lshlrev_b32 v200, 16, v20
    v_and_b32 v201, 0xffff0000, v20
    v_fmac_f32 v176, v211, v200
    v_fmac_f32 v177, v211, v201

    v_lshlrev_b32 v202, 16, v21
    v_and_b32 v203, 0xffff0000, v21
    v_fmac_f32 v178, v211, v202
    v_fmac_f32 v179, v211, v203

    v_lshlrev_b32 v200, 16, v22
    v_and_b32 v201, 0xffff0000, v22
    v_fmac_f32 v180, v211, v200
    v_fmac_f32 v181, v211, v201

    v_lshlrev_b32 v202, 16, v23
    v_and_b32 v203, 0xffff0000, v23
    v_fmac_f32 v182, v211, v202
    v_fmac_f32 v183, v211, v203

L_fc_r3_u1:
    v_sub_f32 v204, v96, v196
    v_sub_f32 v205, v98, v197
    v_exp_f32 v204, v204
    v_exp_f32 v205, v205
    s_nop 0
    v_fmac_f32 v194, v204, v97
    v_fmac_f32 v195, v205, v99
    s_waitcnt vmcnt(2)
    v_lshlrev_b32 v200, 16, v0
    v_and_b32 v201, 0xffff0000, v0
    v_fmac_f32 v160, v204, v200
    v_fmac_f32 v161, v204, v201

    v_lshlrev_b32 v202, 16, v1
    v_and_b32 v203, 0xffff0000, v1
    v_fmac_f32 v162, v204, v202
    v_fmac_f32 v163, v204, v203

    v_lshlrev_b32 v200, 16, v2
    v_and_b32 v201, 0xffff0000, v2
    v_fmac_f32 v164, v204, v200
    v_fmac_f32 v165, v204, v201

    v_lshlrev_b32 v202, 16, v3
    v_and_b32 v203, 0xffff0000, v3
    v_fmac_f32 v166, v204, v202
    v_fmac_f32 v167, v204, v203

    v_cndmask_b32 v211, v204, v205, s[66:67]
    s_waitcnt vmcnt(1)
    v_lshlrev_b32 v200, 16, v4
    v_and_b32 v201, 0xffff0000, v4
    v_fmac_f32 v168, v211, v200
    v_fmac_f32 v169, v211, v201

    v_lshlrev_b32 v202, 16, v5
    v_and_b32 v203, 0xffff0000, v5
    v_fmac_f32 v170, v211, v202
    v_fmac_f32 v171, v211, v203

    v_lshlrev_b32 v200, 16, v6
    v_and_b32 v201, 0xffff0000, v6
    v_fmac_f32 v172, v211, v200
    v_fmac_f32 v173, v211, v201

    v_lshlrev_b32 v202, 16, v7
    v_and_b32 v203, 0xffff0000, v7
    v_fmac_f32 v174, v211, v202
    v_fmac_f32 v175, v211, v203

    v_cndmask_b32 v211, v204, v205, s[76:77]
    s_waitcnt vmcnt(0)
    v_lshlrev_b32 v200, 16, v8
    v_and_b32 v201, 0xffff0000, v8
    v_fmac_f32 v176, v211, v200
    v_fmac_f32 v177, v211, v201

    v_lshlrev_b32 v202, 16, v9
    v_and_b32 v203, 0xffff0000, v9
    v_fmac_f32 v178, v211, v202
    v_fmac_f32 v179, v211, v203

    v_lshlrev_b32 v200, 16, v10
    v_and_b32 v201, 0xffff0000, v10
    v_fmac_f32 v180, v211, v200
    v_fmac_f32 v181, v211, v201

    v_lshlrev_b32 v202, 16, v11
    v_and_b32 v203, 0xffff0000, v11
    v_fmac_f32 v182, v211, v202
    v_fmac_f32 v183, v211, v203

L_fc_r3_u0:
    s_cmp_lg_u64 s[62:63], s[56:57]
    s_cbranch_scc1 L_fc_poll

L_fc_store:
    v_rcp_f32 v198, v194
    v_rcp_f32 v199, v195
    s_lshl_b32 s60, s80, 2
    s_add_u32 s60, s60, s41
    s_lshl_b32 s60, s60, 16

    s_add_u32 s61, s86, 0
    s_lshr_b32 s62, s61, 3
    s_lshl_b32 s62, s62, 13
    s_and_b32 s61, s61, 7
    s_lshl_b32 s61, s61, 5
    s_add_u32 s61, s61, s62
    s_add_u32 s61, s61, s60

    v_mul_f32 v160, v160, v198
    v_mul_f32 v161, v161, v198
    v_mul_f32 v162, v162, v198
    v_mul_f32 v163, v163, v198
    v_mul_f32 v164, v164, v198
    v_mul_f32 v165, v165, v198
    v_mul_f32 v166, v166, v198
    v_mul_f32 v167, v167, v198
    v_cvt_pk_bf16_f32 v160, v160, v161
    v_cvt_pk_bf16_f32 v161, v162, v163
    v_cvt_pk_bf16_f32 v162, v164, v165
    v_cvt_pk_bf16_f32 v163, v166, v167
    s_nop 1
    v_permlane32_swap_b32 v160, v162
    v_permlane32_swap_b32 v161, v163
    buffer_store_dwordx4 v[160:163], v208, s[32:35], s61 offen sc1

    s_cmp_le_u32 s69, 1
    s_cbranch_scc1 L_fc_next
    v_cndmask_b32 v211, v198, v199, s[66:67]

    s_add_u32 s61, s86, 1
    s_lshr_b32 s62, s61, 3
    s_lshl_b32 s62, s62, 13
    s_and_b32 s61, s61, 7
    s_lshl_b32 s61, s61, 5
    s_add_u32 s61, s61, s62
    s_add_u32 s61, s61, s60

    v_mul_f32 v168, v168, v211
    v_mul_f32 v169, v169, v211
    v_mul_f32 v170, v170, v211
    v_mul_f32 v171, v171, v211
    v_mul_f32 v172, v172, v211
    v_mul_f32 v173, v173, v211
    v_mul_f32 v174, v174, v211
    v_mul_f32 v175, v175, v211
    v_cvt_pk_bf16_f32 v168, v168, v169
    v_cvt_pk_bf16_f32 v169, v170, v171
    v_cvt_pk_bf16_f32 v170, v172, v173
    v_cvt_pk_bf16_f32 v171, v174, v175
    s_nop 1
    v_permlane32_swap_b32 v168, v170
    v_permlane32_swap_b32 v169, v171
    buffer_store_dwordx4 v[168:171], v208, s[32:35], s61 offen sc1

    s_cmp_le_u32 s69, 2
    s_cbranch_scc1 L_fc_next
    v_cndmask_b32 v211, v198, v199, s[76:77]

    s_add_u32 s61, s86, 2
    s_lshr_b32 s62, s61, 3
    s_lshl_b32 s62, s62, 13
    s_and_b32 s61, s61, 7
    s_lshl_b32 s61, s61, 5
    s_add_u32 s61, s61, s62
    s_add_u32 s61, s61, s60

    v_mul_f32 v176, v176, v211
    v_mul_f32 v177, v177, v211
    v_mul_f32 v178, v178, v211
    v_mul_f32 v179, v179, v211
    v_mul_f32 v180, v180, v211
    v_mul_f32 v181, v181, v211
    v_mul_f32 v182, v182, v211
    v_mul_f32 v183, v183, v211
    v_cvt_pk_bf16_f32 v176, v176, v177
    v_cvt_pk_bf16_f32 v177, v178, v179
    v_cvt_pk_bf16_f32 v178, v180, v181
    v_cvt_pk_bf16_f32 v179, v182, v183
    s_nop 1
    v_permlane32_swap_b32 v176, v178
    v_permlane32_swap_b32 v177, v179
    buffer_store_dwordx4 v[176:179], v208, s[32:35], s61 offen sc1

L_fc_next:
    s_add_u32 s86, s86, 3
    s_cmp_lt_u32 s86, s87
    s_nop 1
    s_cbranch_scc1 L_fc_outer

L_fc_end:
L_end:
    s_endpgm
L_patch_p0:
    s_call_b64 s[58:59], L_sub_patch
    s_branch L_patch_ret_p0
L_fb0_p0:
    s_call_b64 s[58:59], L_sub_fb0
    s_branch L_fb0_ret_p0
L_fb1_p0:
    s_call_b64 s[58:59], L_sub_fb1
    s_branch L_fb1_ret_p0
L_patch_p1:
    s_call_b64 s[58:59], L_sub_patch
    s_branch L_patch_ret_p1
L_fb0_p1:
    s_call_b64 s[58:59], L_sub_fb0
    s_branch L_fb0_ret_p1
L_fb1_p1:
    s_call_b64 s[58:59], L_sub_fb1
    s_branch L_fb1_ret_p1
L_patch_p2:
    s_call_b64 s[58:59], L_sub_patch
    s_branch L_patch_ret_p2
L_fb0_p2:
    s_call_b64 s[58:59], L_sub_fb0
    s_branch L_fb0_ret_p2
L_fb1_p2:
    s_call_b64 s[58:59], L_sub_fb1
    s_branch L_fb1_ret_p2
L_patch_0:
    s_call_b64 s[58:59], L_sub_patch
    s_branch L_patch_ret_0
L_fb0_0:
    s_call_b64 s[58:59], L_sub_fb0
    s_branch L_fb0_ret_0
L_fb1_0:
    s_call_b64 s[58:59], L_sub_fb1
    s_branch L_fb1_ret_0
L_patch_1:
    s_call_b64 s[58:59], L_sub_patch
    s_branch L_patch_ret_1
L_fb0_1:
    s_call_b64 s[58:59], L_sub_fb0
    s_branch L_fb0_ret_1
L_fb1_1:
    s_call_b64 s[58:59], L_sub_fb1
    s_branch L_fb1_ret_1
L_patch_2:
    s_call_b64 s[58:59], L_sub_patch
    s_branch L_patch_ret_2
L_fb0_2:
    s_call_b64 s[58:59], L_sub_fb0
    s_branch L_fb0_ret_2
L_fb1_2:
    s_call_b64 s[58:59], L_sub_fb1
    s_branch L_fb1_ret_2
L_patch_3:
    s_call_b64 s[58:59], L_sub_patch
    s_branch L_patch_ret_3
L_fb0_3:
    s_call_b64 s[58:59], L_sub_fb0
    s_branch L_fb0_ret_3
L_fb1_3:
    s_call_b64 s[58:59], L_sub_fb1
    s_branch L_fb1_ret_3
L_patch_4:
    s_call_b64 s[58:59], L_sub_patch
    s_branch L_patch_ret_4
L_fb0_4:
    s_call_b64 s[58:59], L_sub_fb0
    s_branch L_fb0_ret_4
L_fb1_4:
    s_call_b64 s[58:59], L_sub_fb1
    s_branch L_fb1_ret_4
L_patch_5:
    s_call_b64 s[58:59], L_sub_patch
    s_branch L_patch_ret_5
L_fb0_5:
    s_call_b64 s[58:59], L_sub_fb0
    s_branch L_fb0_ret_5
L_fb1_5:
    s_call_b64 s[58:59], L_sub_fb1
    s_branch L_fb1_ret_5
L_patch_6:
    s_call_b64 s[58:59], L_sub_patch
    s_branch L_patch_ret_6
L_fb0_6:
    s_call_b64 s[58:59], L_sub_fb0
    s_branch L_fb0_ret_6
L_fb1_6:
    s_call_b64 s[58:59], L_sub_fb1
    s_branch L_fb1_ret_6
L_patch_7:
    s_call_b64 s[58:59], L_sub_patch
    s_branch L_patch_ret_7
L_fb0_7:
    s_call_b64 s[58:59], L_sub_fb0
    s_branch L_fb0_ret_7
L_fb1_7:
    s_call_b64 s[58:59], L_sub_fb1
    s_branch L_fb1_ret_7
L_code_end:
L_sub_fb0:
    s_nop 7
    v_max3_f32 v240, v0, v1, v2
    v_max3_f32 v240, v240, v3, v4
    v_max3_f32 v240, v240, v5, v6
    v_max3_f32 v240, v240, v7, v8
    v_max3_f32 v240, v240, v9, v10
    v_max3_f32 v240, v240, v11, v12
    v_max3_f32 v240, v240, v13, v14
    v_max_f32 v240, v240, v15
    v_mov_b32 v241, v240
    s_nop 1
    v_permlane32_swap_b32 v240, v241
    s_nop 1
    v_max_f32 v240, v240, v241
    v_max_f32 v240, 0, v240
    v_exp_f32 v243, -v240
    v_add_f32 v227, v227, v240

    v_sub_f32 v32, v32, v240
    v_sub_f32 v0, v0, v240
    v_sub_f32 v33, v33, v240
    v_sub_f32 v1, v1, v240
    v_sub_f32 v34, v34, v240
    v_sub_f32 v2, v2, v240
    v_sub_f32 v35, v35, v240
    v_sub_f32 v3, v3, v240
    v_sub_f32 v36, v36, v240
    v_sub_f32 v4, v4, v240
    v_sub_f32 v37, v37, v240
    v_sub_f32 v5, v5, v240
    v_sub_f32 v38, v38, v240
    v_sub_f32 v6, v6, v240
    v_sub_f32 v39, v39, v240
    v_sub_f32 v7, v7, v240
    v_sub_f32 v40, v40, v240
    v_sub_f32 v8, v8, v240
    v_sub_f32 v41, v41, v240
    v_sub_f32 v9, v9, v240
    v_sub_f32 v42, v42, v240
    v_sub_f32 v10, v10, v240
    v_sub_f32 v43, v43, v240
    v_sub_f32 v11, v11, v240
    v_sub_f32 v44, v44, v240
    v_sub_f32 v12, v12, v240
    v_sub_f32 v45, v45, v240
    v_sub_f32 v13, v13, v240
    v_sub_f32 v46, v46, v240
    v_sub_f32 v14, v14, v240
    v_sub_f32 v47, v47, v240
    v_sub_f32 v15, v15, v240
    v_mul_f32 v225, v225, v243
    v_mul_f32 v64, v64, v243
    v_mul_f32 v65, v65, v243
    v_mul_f32 v66, v66, v243
    v_mul_f32 v67, v67, v243
    v_mul_f32 v68, v68, v243
    v_mul_f32 v69, v69, v243
    v_mul_f32 v70, v70, v243
    v_mul_f32 v71, v71, v243
    v_mul_f32 v72, v72, v243
    v_mul_f32 v73, v73, v243
    v_mul_f32 v74, v74, v243
    v_mul_f32 v75, v75, v243
    v_mul_f32 v76, v76, v243
    v_mul_f32 v77, v77, v243
    v_mul_f32 v78, v78, v243
    v_mul_f32 v79, v79, v243
    v_mul_f32 v80, v80, v243
    v_mul_f32 v81, v81, v243
    v_mul_f32 v82, v82, v243
    v_mul_f32 v83, v83, v243
    v_mul_f32 v84, v84, v243
    v_mul_f32 v85, v85, v243
    v_mul_f32 v86, v86, v243
    v_mul_f32 v87, v87, v243
    v_mul_f32 v88, v88, v243
    v_mul_f32 v89, v89, v243
    v_mul_f32 v90, v90, v243
    v_mul_f32 v91, v91, v243
    v_mul_f32 v92, v92, v243
    v_mul_f32 v93, v93, v243
    v_mul_f32 v94, v94, v243
    v_mul_f32 v95, v95, v243
    v_mul_f32 v96, v96, v243
    v_mul_f32 v97, v97, v243
    v_mul_f32 v98, v98, v243
    v_mul_f32 v99, v99, v243
    v_mul_f32 v100, v100, v243
    v_mul_f32 v101, v101, v243
    v_mul_f32 v102, v102, v243
    v_mul_f32 v103, v103, v243
    v_mul_f32 v104, v104, v243
    v_mul_f32 v105, v105, v243
    v_mul_f32 v106, v106, v243
    v_mul_f32 v107, v107, v243
    v_mul_f32 v108, v108, v243
    v_mul_f32 v109, v109, v243
    v_mul_f32 v110, v110, v243
    v_mul_f32 v111, v111, v243
    v_mul_f32 v112, v112, v243
    v_mul_f32 v113, v113, v243
    v_mul_f32 v114, v114, v243
    v_mul_f32 v115, v115, v243
    v_mul_f32 v116, v116, v243
    v_mul_f32 v117, v117, v243
    v_mul_f32 v118, v118, v243
    v_mul_f32 v119, v119, v243
    v_mul_f32 v120, v120, v243
    v_mul_f32 v121, v121, v243
    v_mul_f32 v122, v122, v243
    v_mul_f32 v123, v123, v243
    v_mul_f32 v124, v124, v243
    v_mul_f32 v125, v125, v243
    v_mul_f32 v126, v126, v243
    v_mul_f32 v127, v127, v243
    v_exp_f32 v229, v0
    v_exp_f32 v230, v1
    v_exp_f32 v244, v2
    v_cvt_pk_bf16_f32 v192, v229, v230
    v_exp_f32 v245, v3
    v_add_f32 v229, v229, v244
    v_exp_f32 v246, v4
    v_add_f32 v230, v230, v245
    v_cvt_pk_bf16_f32 v193, v244, v245
    v_exp_f32 v247, v5
    v_add_f32 v229, v229, v246
    v_exp_f32 v248, v6
    v_add_f32 v230, v230, v247
    v_cvt_pk_bf16_f32 v194, v246, v247
    v_exp_f32 v249, v7
    v_add_f32 v229, v229, v248
    v_exp_f32 v244, v8
    v_add_f32 v230, v230, v249
    v_cvt_pk_bf16_f32 v195, v248, v249
    v_exp_f32 v245, v9
    v_add_f32 v229, v229, v244
    v_exp_f32 v246, v10
    v_add_f32 v230, v230, v245
    v_cvt_pk_bf16_f32 v196, v244, v245
    v_exp_f32 v247, v11
    v_add_f32 v229, v229, v246
    v_exp_f32 v248, v12
    v_add_f32 v230, v230, v247
    v_cvt_pk_bf16_f32 v197, v246, v247
    v_exp_f32 v249, v13
    v_add_f32 v229, v229, v248
    v_exp_f32 v244, v14
    v_add_f32 v230, v230, v249
    v_cvt_pk_bf16_f32 v198, v248, v249
    v_exp_f32 v245, v15
    v_add_f32 v229, v229, v244
    v_add_f32 v230, v230, v245
    v_cvt_pk_bf16_f32 v199, v244, v245
    v_add_f32 v229, v229, v230
    s_nop 3
    s_setpc_b64 s[58:59]

L_sub_fb1:
    s_nop 7
    v_max3_f32 v240, v16, v17, v18
    v_max3_f32 v240, v240, v19, v20
    v_max3_f32 v240, v240, v21, v22
    v_max3_f32 v240, v240, v23, v24
    v_max3_f32 v240, v240, v25, v26
    v_max3_f32 v240, v240, v27, v28
    v_max3_f32 v240, v240, v29, v30
    v_max_f32 v240, v240, v31
    v_mov_b32 v241, v240
    s_nop 1
    v_permlane32_swap_b32 v240, v241
    s_nop 1
    v_max_f32 v240, v240, v241
    v_max_f32 v240, 0, v240
    v_exp_f32 v243, -v240
    v_add_f32 v228, v228, v240

    v_sub_f32 v48, v48, v240
    v_sub_f32 v16, v16, v240
    v_sub_f32 v49, v49, v240
    v_sub_f32 v17, v17, v240
    v_sub_f32 v50, v50, v240
    v_sub_f32 v18, v18, v240
    v_sub_f32 v51, v51, v240
    v_sub_f32 v19, v19, v240
    v_sub_f32 v52, v52, v240
    v_sub_f32 v20, v20, v240
    v_sub_f32 v53, v53, v240
    v_sub_f32 v21, v21, v240
    v_sub_f32 v54, v54, v240
    v_sub_f32 v22, v22, v240
    v_sub_f32 v55, v55, v240
    v_sub_f32 v23, v23, v240
    v_sub_f32 v56, v56, v240
    v_sub_f32 v24, v24, v240
    v_sub_f32 v57, v57, v240
    v_sub_f32 v25, v25, v240
    v_sub_f32 v58, v58, v240
    v_sub_f32 v26, v26, v240
    v_sub_f32 v59, v59, v240
    v_sub_f32 v27, v27, v240
    v_sub_f32 v60, v60, v240
    v_sub_f32 v28, v28, v240
    v_sub_f32 v61, v61, v240
    v_sub_f32 v29, v29, v240
    v_sub_f32 v62, v62, v240
    v_sub_f32 v30, v30, v240
    v_sub_f32 v63, v63, v240
    v_sub_f32 v31, v31, v240
    v_mul_f32 v226, v226, v243
    v_mul_f32 v128, v128, v243
    v_mul_f32 v129, v129, v243
    v_mul_f32 v130, v130, v243
    v_mul_f32 v131, v131, v243
    v_mul_f32 v132, v132, v243
    v_mul_f32 v133, v133, v243
    v_mul_f32 v134, v134, v243
    v_mul_f32 v135, v135, v243
    v_mul_f32 v136, v136, v243
    v_mul_f32 v137, v137, v243
    v_mul_f32 v138, v138, v243
    v_mul_f32 v139, v139, v243
    v_mul_f32 v140, v140, v243
    v_mul_f32 v141, v141, v243
    v_mul_f32 v142, v142, v243
    v_mul_f32 v143, v143, v243
    v_mul_f32 v144, v144, v243
    v_mul_f32 v145, v145, v243
    v_mul_f32 v146, v146, v243
    v_mul_f32 v147, v147, v243
    v_mul_f32 v148, v148, v243
    v_mul_f32 v149, v149, v243
    v_mul_f32 v150, v150, v243
    v_mul_f32 v151, v151, v243
    v_mul_f32 v152, v152, v243
    v_mul_f32 v153, v153, v243
    v_mul_f32 v154, v154, v243
    v_mul_f32 v155, v155, v243
    v_mul_f32 v156, v156, v243
    v_mul_f32 v157, v157, v243
    v_mul_f32 v158, v158, v243
    v_mul_f32 v159, v159, v243
    v_mul_f32 v160, v160, v243
    v_mul_f32 v161, v161, v243
    v_mul_f32 v162, v162, v243
    v_mul_f32 v163, v163, v243
    v_mul_f32 v164, v164, v243
    v_mul_f32 v165, v165, v243
    v_mul_f32 v166, v166, v243
    v_mul_f32 v167, v167, v243
    v_mul_f32 v168, v168, v243
    v_mul_f32 v169, v169, v243
    v_mul_f32 v170, v170, v243
    v_mul_f32 v171, v171, v243
    v_mul_f32 v172, v172, v243
    v_mul_f32 v173, v173, v243
    v_mul_f32 v174, v174, v243
    v_mul_f32 v175, v175, v243
    v_mul_f32 v176, v176, v243
    v_mul_f32 v177, v177, v243
    v_mul_f32 v178, v178, v243
    v_mul_f32 v179, v179, v243
    v_mul_f32 v180, v180, v243
    v_mul_f32 v181, v181, v243
    v_mul_f32 v182, v182, v243
    v_mul_f32 v183, v183, v243
    v_mul_f32 v184, v184, v243
    v_mul_f32 v185, v185, v243
    v_mul_f32 v186, v186, v243
    v_mul_f32 v187, v187, v243
    v_mul_f32 v188, v188, v243
    v_mul_f32 v189, v189, v243
    v_mul_f32 v190, v190, v243
    v_mul_f32 v191, v191, v243
    v_exp_f32 v231, v16
    v_exp_f32 v232, v17
    v_exp_f32 v244, v18
    v_cvt_pk_bf16_f32 v200, v231, v232
    v_exp_f32 v245, v19
    v_add_f32 v231, v231, v244
    v_exp_f32 v246, v20
    v_add_f32 v232, v232, v245
    v_cvt_pk_bf16_f32 v201, v244, v245
    v_exp_f32 v247, v21
    v_add_f32 v231, v231, v246
    v_exp_f32 v248, v22
    v_add_f32 v232, v232, v247
    v_cvt_pk_bf16_f32 v202, v246, v247
    v_exp_f32 v249, v23
    v_add_f32 v231, v231, v248
    v_exp_f32 v244, v24
    v_add_f32 v232, v232, v249
    v_cvt_pk_bf16_f32 v203, v248, v249
    v_exp_f32 v245, v25
    v_add_f32 v231, v231, v244
    v_exp_f32 v246, v26
    v_add_f32 v232, v232, v245
    v_cvt_pk_bf16_f32 v204, v244, v245
    v_exp_f32 v247, v27
    v_add_f32 v231, v231, v246
    v_exp_f32 v248, v28
    v_add_f32 v232, v232, v247
    v_cvt_pk_bf16_f32 v205, v246, v247
    v_exp_f32 v249, v29
    v_add_f32 v231, v231, v248
    v_exp_f32 v244, v30
    v_add_f32 v232, v232, v249
    v_cvt_pk_bf16_f32 v206, v248, v249
    v_exp_f32 v245, v31
    v_add_f32 v231, v231, v244
    v_add_f32 v232, v232, v245
    v_cvt_pk_bf16_f32 v207, v244, v245
    v_add_f32 v231, v231, v232
    s_nop 3
    s_setpc_b64 s[58:59]

L_sub_patch:
    s_nop 7
    v_mov_b32 v240, 0xff800000

    s_sub_i32 s75, s46, 0
    v_cmp_gt_i32 vcc, s75, v255
    s_nop 1
    v_cndmask_b32 v32, v240, v32, vcc
    v_cndmask_b32 v48, v240, v48, vcc

    s_sub_i32 s75, s46, 1
    v_cmp_gt_i32 vcc, s75, v255
    s_nop 1
    v_cndmask_b32 v33, v240, v33, vcc
    v_cndmask_b32 v49, v240, v49, vcc

    s_sub_i32 s75, s46, 2
    v_cmp_gt_i32 vcc, s75, v255
    s_nop 1
    v_cndmask_b32 v34, v240, v34, vcc
    v_cndmask_b32 v50, v240, v50, vcc

    s_sub_i32 s75, s46, 3
    v_cmp_gt_i32 vcc, s75, v255
    s_nop 1
    v_cndmask_b32 v35, v240, v35, vcc
    v_cndmask_b32 v51, v240, v51, vcc

    s_sub_i32 s75, s46, 8
    v_cmp_gt_i32 vcc, s75, v255
    s_nop 1
    v_cndmask_b32 v36, v240, v36, vcc
    v_cndmask_b32 v52, v240, v52, vcc

    s_sub_i32 s75, s46, 9
    v_cmp_gt_i32 vcc, s75, v255
    s_nop 1
    v_cndmask_b32 v37, v240, v37, vcc
    v_cndmask_b32 v53, v240, v53, vcc

    s_sub_i32 s75, s46, 10
    v_cmp_gt_i32 vcc, s75, v255
    s_nop 1
    v_cndmask_b32 v38, v240, v38, vcc
    v_cndmask_b32 v54, v240, v54, vcc

    s_sub_i32 s75, s46, 11
    v_cmp_gt_i32 vcc, s75, v255
    s_nop 1
    v_cndmask_b32 v39, v240, v39, vcc
    v_cndmask_b32 v55, v240, v55, vcc

    s_sub_i32 s75, s46, 16
    v_cmp_gt_i32 vcc, s75, v255
    s_nop 1
    v_cndmask_b32 v40, v240, v40, vcc
    v_cndmask_b32 v56, v240, v56, vcc

    s_sub_i32 s75, s46, 17
    v_cmp_gt_i32 vcc, s75, v255
    s_nop 1
    v_cndmask_b32 v41, v240, v41, vcc
    v_cndmask_b32 v57, v240, v57, vcc

    s_sub_i32 s75, s46, 18
    v_cmp_gt_i32 vcc, s75, v255
    s_nop 1
    v_cndmask_b32 v42, v240, v42, vcc
    v_cndmask_b32 v58, v240, v58, vcc

    s_sub_i32 s75, s46, 19
    v_cmp_gt_i32 vcc, s75, v255
    s_nop 1
    v_cndmask_b32 v43, v240, v43, vcc
    v_cndmask_b32 v59, v240, v59, vcc

    s_sub_i32 s75, s46, 24
    v_cmp_gt_i32 vcc, s75, v255
    s_nop 1
    v_cndmask_b32 v44, v240, v44, vcc
    v_cndmask_b32 v60, v240, v60, vcc

    s_sub_i32 s75, s46, 25
    v_cmp_gt_i32 vcc, s75, v255
    s_nop 1
    v_cndmask_b32 v45, v240, v45, vcc
    v_cndmask_b32 v61, v240, v61, vcc

    s_sub_i32 s75, s46, 26
    v_cmp_gt_i32 vcc, s75, v255
    s_nop 1
    v_cndmask_b32 v46, v240, v46, vcc
    v_cndmask_b32 v62, v240, v62, vcc

    s_sub_i32 s75, s46, 27
    v_cmp_gt_i32 vcc, s75, v255
    s_nop 1
    v_cndmask_b32 v47, v240, v47, vcc
    v_cndmask_b32 v63, v240, v63, vcc

    s_nop 3
    s_setpc_b64 s[58:59]

.section .rodata,"a"

.p2align 6
.amdhsa_kernel standalone__paged_block_table_kv_pagedattention__sampling_kernel
  .amdhsa_next_free_vgpr 384
  .amdhsa_next_free_sgpr 102
  .amdhsa_accum_offset 256
  .amdhsa_group_segment_fixed_size 0
  .amdhsa_kernarg_size 64
  .amdhsa_user_sgpr_count 2
  .amdhsa_user_sgpr_kernarg_segment_ptr 1
  .amdhsa_system_sgpr_workgroup_id_x 1
.end_amdhsa_kernel
```
